```python
import torch

def _softmax(x, axis=-1):
    return torch.softmax(x, dim=axis)

def _gelu(x):
    return torch.nn.functional.gelu(x, approximate='tanh')

def _silu(x):
    return torch.nn.functional.silu(x)

def _sigmoid(x):
    return torch.sigmoid(x)

def _layernorm(x, axis=-1, eps=1e-05):
    m = x.mean(dim=axis, keepdim=True)
    v = x.var(dim=axis, keepdim=True, unbiased=False)
    return (x - m) / torch.sqrt(v + eps)

def _scatter_add(tgt, idx, src, axis=0):
    return tgt.clone().index_add_(axis, idx, src)

def _segment_sum(src, seg, n):
    out = torch.zeros((n,) + src.shape[1:], dtype=src.dtype)
    return out.index_add_(0, seg, src)

def _pad(x, pw):
    flat = tuple((v for pair in reversed(pw) for v in pair))
    return torch.nn.functional.pad(x, flat)
kernel_name = 'standalone__tensor_product_equiv_equiformer__graph'

def setup_inputs():

    _w = lambda a: (lambda t: t.to(torch.bfloat16) if t.is_floating_point() else t)(torch.as_tensor(a))
    N, deg, C, De = (10000, 32, 128, max(0, 1))
    E = N * deg
    src = (lambda lo, hi, *s: torch.randint(lo, hi, s))(0, N, E).to(torch.int64)
    dst = (lambda lo, hi, *s: torch.randint(lo, hi, s))(0, N, E).to(torch.int64)
    rvec = (lambda *s: torch.randn(*s, dtype=torch.bfloat16) * 0.05)(E, 3).to(float)
    rn = (torch.linalg.norm(rvec, dim=-1, keepdim=True) + 1e-06).to(float)
    rhat = (rvec / rn).to(float)
    eps = torch.zeros((3, 3, 3), dtype=float)
    eps[0, 1, 2] = eps[1, 2, 0] = eps[2, 0, 1] = 1.0
    eps[0, 2, 1] = eps[2, 1, 0] = eps[1, 0, 2] = -1.0
    return {'x': _w((lambda *s: torch.randn(*s, dtype=torch.bfloat16) * 0.4)(N, 4 * C).to(float)), 'rhat': _w(rhat), 'e_attr': _w((lambda *s: torch.randn(*s, dtype=torch.bfloat16) * 0.4)(E, De).to(float)), 'src': _w(src), 'dst': _w(dst), 'w_rad': _w((lambda *s: torch.randn(*s, dtype=torch.bfloat16) * 0.4)(De, 5 * C).to(float)), 'w_si0': _w((lambda *s: torch.randn(*s, dtype=torch.bfloat16) * 0.4)(2 * C, C).to(float)), 'w_si1': _w((lambda *s: torch.randn(*s, dtype=torch.bfloat16) * 0.05)(3 * C, C).to(float)), 'cg_eps': _w(eps)}

def reference(x, rhat, e_attr, src, dst, w_rad, w_si0, w_si1, cg_eps):
    N = x.shape[0]
    C = w_si0.shape[1]
    E = rhat.shape[0]
    x0 = x[:, :C].clone()
    x1 = x[:, C:].reshape(N, 3, C)
    R = (e_attr @ w_rad).reshape(E, 5, C)
    f0 = x0[src]
    f1 = x1[src]
    Y1 = rhat
    p00_0 = f0 * R[:, 0, :]
    p11_0 = torch.einsum('ejc,ej->ec', f1, Y1) * R[:, 1, :]
    p01_1 = torch.einsum('ec,ej->ejc', f0, Y1) * R[:, 2, :][:, None, :]
    p10_1 = f1 * R[:, 3, :][:, None, :]
    p11_1 = torch.einsum('ijk,ekc,ej->eic', cg_eps, f1, Y1) * R[:, 4, :][:, None, :]
    m0 = torch.concatenate([p00_0, p11_0], axis=-1) @ w_si0
    m1 = torch.einsum('ejp,pc->ejc', torch.concatenate([p01_1, p10_1, p11_1], axis=-1), w_si1)
    agg0 = _segment_sum(m0, dst, N)
    agg1 = _segment_sum(m1.reshape(E, 3 * C), dst, N).reshape(N, 3, C)
    gate = _sigmoid(agg0)
    out1 = agg1 * gate[:, None, :]
    return torch.concatenate([agg0, out1.reshape(N, 3 * C)], axis=-1)
```

```asm
; @launch grid=(250,1,1) block=(640,1,1) lds=151808
.amdgcn_target "amdgcn-amd-amdhsa--gfx950"
.text
.globl standalone__tensor_product_equiv_equiformer__graph_kernel
.p2align 8
.type standalone__tensor_product_equiv_equiformer__graph_kernel,@function
standalone__tensor_product_equiv_equiformer__graph_kernel:
    s_cmp_ge_u32 s2, 250
    s_cbranch_scc1 K2_done
    s_cmp_ge_u32 s2, 176
    s_cbranch_scc1 FU_idle
    s_load_dwordx4 s[4:7], s[0:1], 0
    s_load_dwordx4 s[8:11], s[0:1], 16
    s_load_dwordx4 s[12:15], s[0:1], 32
    s_load_dwordx4 s[16:19], s[0:1], 48
    s_load_dwordx2 s[20:21], s[0:1], 88
    s_load_dwordx2 s[58:59], s[0:1], 80
    s_load_dwordx2 s[68:69], s[0:1], 72
    s_cmp_ge_u32 s2, 160
    s_cbranch_scc1 K1_helper
    v_lshlrev_b32 v1, 2, v0
    v_mov_b32 v2, 0
    v_cmp_gt_u32 vcc, 0x100, v0
    s_and_saveexec_b64 s[22:23], vcc
    ds_write_b32 v1, v2 offset:32768
    s_mov_b64 exec, s[22:23]
    v_lshlrev_b32 v1, 4, v0
    v_mul_u32_u24 v2, 24, v0
    v_lshlrev_b32 v3, 3, v0
    s_mul_i32 s44, s2, 8000
    s_mul_i32 s45, s2, 12000
    s_mul_i32 s46, s2, 4000
    v_cmp_gt_u32 vcc, 0x1f4, v0
    s_waitcnt lgkmcnt(0)
    s_mov_b32 s24, s10
    s_mov_b32 s25, s11
    s_mov_b32 s26, 1280000
    s_mov_b32 s27, 0x20000
    s_mov_b32 s28, s12
    s_mov_b32 s29, s13
    s_mov_b32 s30, 1280000
    s_mov_b32 s31, 0x20000
    s_mov_b32 s32, s6
    s_mov_b32 s33, s7
    s_mov_b32 s34, 1920000
    s_mov_b32 s35, 0x20000
    s_mov_b32 s36, s8
    s_mov_b32 s37, s9
    s_mov_b32 s38, 640000
    s_mov_b32 s39, 0x20000
    s_mov_b32 s40, s20
    s_mov_b32 s41, s21
    s_mov_b32 s42, 5734656
    s_mov_b32 s43, 0x20000
    v_readfirstlane_b32 s52, v0
    v_mov_b32 v60, 491520
    buffer_load_dword v73, v60, s[40:43], 0 offen sc1
    s_and_saveexec_b64 s[48:49], vcc
    s_mov_b64 s[50:51], exec
    buffer_load_dwordx4 v[8:11], v1, s[28:31], s44 offen
    buffer_load_dwordx4 v[4:7], v1, s[24:27], s44 offen
    buffer_load_dwordx2 v[18:19], v3, s[36:39], s46 offen
    buffer_load_dwordx4 v[12:15], v2, s[32:35], s45 offen
    buffer_load_dwordx2 v[16:17], v2, s[32:35], s45 offen offset:16
    s_mov_b64 exec, s[48:49]
    v_lshrrev_b32 v87, 6, v0
    v_mbcnt_lo_u32_b32 v76, -1, 0
    v_mbcnt_hi_u32_b32 v76, -1, v76
    v_readfirstlane_b32 s64, v87
    v_lshrrev_b32 v77, 2, v0
    v_and_b32 v78, 3, v0
    v_lshlrev_b32 v79, 11, v77
    s_mul_i32 s65, s64, 12288
    s_mul_i32 s66, s64, 512
    s_add_u32 s66, s66, 143424
    s_lshl_b32 s67, s64, 2
    v_mov_b32 v116, 0
    v_mov_b32 v117, 0
    v_mov_b32 v118, 0
    v_mov_b32 v119, 0
    v_mov_b32 v120, 0
    v_mov_b32 v121, 0
    v_mov_b32 v122, 0
    v_mov_b32 v123, 0
    v_mov_b32 v124, 0
    v_mov_b32 v125, 0
    v_mov_b32 v126, 0
    v_mov_b32 v127, 0
    v_mov_b32 v128, 0
    v_mov_b32 v129, 0
    v_mov_b32 v130, 0
    v_mov_b32 v131, 0
    v_mov_b32 v132, 0
    v_mov_b32 v133, 0
    v_mov_b32 v134, 0
    v_mov_b32 v135, 0
    v_mov_b32 v136, 0
    v_mov_b32 v137, 0
    v_mov_b32 v138, 0
    v_mov_b32 v139, 0
    v_lshlrev_b32 v83, 4, v76
    v_add_u32 v83, s65, v83
    v_lshlrev_b32 v84, 2, v76
    v_add_u32 v84, s66, v84
    v_mov_b32 v86, -1
    v_and_b32 v89, 15, v76
    v_lshlrev_b32 v85, 2, v89
    v_add_u32 v85, 151104, v85
    v_lshrrev_b32 v90, 4, v76
    v_lshrrev_b32 v91, 2, v89
    v_and_b32 v92, 3, v76
    v_lshl_add_u32 v87, v90, 3, v91
    v_lshlrev_b32 v87, 7, v87
    v_lshl_add_u32 v87, v92, 3, v87
    v_add_u32 v87, s65, v87
    v_lshrrev_b32 v88, 1, v91
    v_and_b32 v93, 1, v90
    v_lshl_add_u32 v88, v93, 1, v88
    v_lshl_add_u32 v81, v88, 5, v87
    v_lshrrev_b32 v87, 3, v76
    v_lshlrev_b32 v87, 2, v87
    v_add_u32 v80, s66, v87
    v_and_b32 v87, 7, v76
    v_lshlrev_b32 v88, 1, v93
    v_xor_b32 v87, v87, v88
    v_lshlrev_b32 v82, 4, v87
    v_add_u32 v87, s67, v91
    v_and_b32 v88, 8, v87
    v_lshrrev_b32 v88, 2, v88
    v_xor_b32 v88, v88, v90
    v_lshlrev_b32 v87, 6, v87
    v_lshl_add_u32 v87, v88, 4, v87
    v_mul_u32_u24 v88, 5136, v92
    v_add_u32 v87, v87, v88
    v_add_u32 v164, 122880, v87
    v_and_b32 v88, 8, v89
    v_lshrrev_b32 v88, 2, v88
    v_xor_b32 v88, v88, v90
    v_lshlrev_b32 v87, 6, v89
    v_lshl_add_u32 v87, v88, 4, v87
    v_add_u32 v165, 122880, v87
    v_lshlrev_b32 v75, 8, v90
    v_lshl_add_u32 v75, v89, 3, v75
    v_add_u32 v75, s65, v75
    v_mov_b32 v140, 0
    v_mov_b32 v141, 0
    v_mov_b32 v142, 0
    v_mov_b32 v143, 0
    v_mov_b32 v144, 0
    v_mov_b32 v145, 0
    v_mov_b32 v146, 0
    v_mov_b32 v147, 0
    v_mov_b32 v148, 0
    v_mov_b32 v149, 0
    v_mov_b32 v150, 0
    v_mov_b32 v151, 0
    v_mov_b32 v152, 0
    v_mov_b32 v153, 0
    v_mov_b32 v154, 0
    v_mov_b32 v155, 0
    v_mov_b32 v156, 0
    v_mov_b32 v157, 0
    v_mov_b32 v158, 0
    v_mov_b32 v159, 0
    v_mov_b32 v160, 0
    v_mov_b32 v161, 0
    v_mov_b32 v162, 0
    v_mov_b32 v163, 0
    s_mov_b32 s8, s4
    s_mov_b32 s9, s5
    s_mov_b32 s10, 10240000
    s_mov_b32 s11, 0x20000
    s_mov_b32 s12, s40
    s_mov_b32 s13, s41
    s_mov_b32 s14, 5734656
    s_mov_b32 s15, 0x20000
    s_mov_b32 s16, s68
    s_mov_b32 s17, s69
    s_mov_b32 s18, 10240000
    s_mov_b32 s19, 0x20000
    s_mov_b32 s20, s64
    s_mul_i32 s29, s64, 10240
    s_add_u32 s29, s29, 327680
    s_mov_b32 s35, 0
    s_mov_b32 s34, 0
    s_mov_b32 s36, 0
    s_mov_b32 s54, 0
    s_and_b32 s67, s2, 7
    s_mul_i32 s66, s67, 31
    s_min_u32 s67, s67, 2
    s_add_u32 s66, s66, s67
    s_lshr_b32 s67, s2, 3
    s_add_u32 s66, s66, s67
    s_getreg_b32 s67, hwreg(HW_REG_HW_ID, 8, 8)
    s_lshr_b32 s53, s67, 4
    s_and_b32 s53, s53, 6
    s_and_b32 s67, s67, 1
    s_or_b32 s67, s67, s53
    s_lshr_b32 s53, s2, 6
    s_lshl_b32 s53, s53, 3
    s_or_b32 s67, s67, s53
    s_lshr_b32 s53, s2, 3
    s_cmp_ge_u32 s2, 192
    s_cselect_b32 s67, s53, s67
    s_barrier
    s_mov_b64 exec, s[50:51]
    s_cbranch_execz K1_pfw
    v_mov_b32 v3, 1
    s_mov_b32 s47, 52429
    s_waitcnt vmcnt(4)
    v_readfirstlane_b32 s63, v73
    s_mul_i32 s63, s63, 1664525
    s_add_u32 s63, s63, 1013904221
    s_or_b32 s63, s63, 1
    v_mul_u32_u24 v20, s47, v8
    v_lshrrev_b32 v20, 21, v20
    v_mul_u32_u24 v24, 40, v20
    v_sub_u32 v24, v8, v24
    v_lshlrev_b32 v20, 2, v20
    ds_add_rtn_u32 v28, v20, v3 offset:32768
    v_mul_u32_u24 v21, s47, v9
    v_lshrrev_b32 v21, 21, v21
    v_mul_u32_u24 v25, 40, v21
    v_sub_u32 v25, v9, v25
    v_lshlrev_b32 v21, 2, v21
    ds_add_rtn_u32 v29, v21, v3 offset:32768
    v_mul_u32_u24 v22, s47, v10
    v_lshrrev_b32 v22, 21, v22
    v_mul_u32_u24 v26, 40, v22
    v_sub_u32 v26, v10, v26
    v_lshlrev_b32 v22, 2, v22
    ds_add_rtn_u32 v30, v22, v3 offset:32768
    v_mul_u32_u24 v23, s47, v11
    v_lshrrev_b32 v23, 21, v23
    v_mul_u32_u24 v27, 40, v23
    v_sub_u32 v27, v11, v27
    v_lshlrev_b32 v23, 2, v23
    ds_add_rtn_u32 v31, v23, v3 offset:32768
    s_waitcnt vmcnt(0)
    s_or_b32 s53, s52, s2
    s_cmp_lg_u32 s53, 0
    s_cbranch_scc1 K1_nosig
    s_mov_b64 s[22:23], exec
    s_mov_b64 exec, 1
    v_mov_b32 v60, 0
    v_mov_b32 v61, s63
    global_store_dword v60, v61, s[58:59] offset:128 sc1
    s_mov_b64 exec, s[22:23]
K1_nosig:
    v_or_b32 v24, 0x2b000000, v24
    v_lshl_or_b32 v32, v4, 10, v24
    v_lshlrev_b32 v48, 16, v18
    v_lshlrev_b32 v49, 16, v12
    v_and_b32 v50, 0xffff0000, v12
    v_lshlrev_b32 v51, 16, v13
    v_mul_f32 v49, v48, v49
    v_mul_f32 v50, v48, v50
    v_mul_f32 v51, v48, v51
    v_cvt_pk_bf16_f32 v33, v48, v49
    v_cvt_pk_bf16_f32 v34, v50, v51
    v_bitop3_b32 v35, v32, v33, v34 bitop3:0x96
    v_xor_b32 v35, s63, v35
    v_or_b32 v25, 0x2b000000, v25
    v_lshl_or_b32 v36, v5, 10, v25
    v_and_b32 v48, 0xffff0000, v18
    v_and_b32 v49, 0xffff0000, v13
    v_lshlrev_b32 v50, 16, v14
    v_and_b32 v51, 0xffff0000, v14
    v_mul_f32 v49, v48, v49
    v_mul_f32 v50, v48, v50
    v_mul_f32 v51, v48, v51
    v_cvt_pk_bf16_f32 v37, v48, v49
    v_cvt_pk_bf16_f32 v38, v50, v51
    v_bitop3_b32 v39, v36, v37, v38 bitop3:0x96
    v_xor_b32 v39, s63, v39
    v_or_b32 v26, 0x2b000000, v26
    v_lshl_or_b32 v40, v6, 10, v26
    v_lshlrev_b32 v48, 16, v19
    v_lshlrev_b32 v49, 16, v15
    v_and_b32 v50, 0xffff0000, v15
    v_lshlrev_b32 v51, 16, v16
    v_mul_f32 v49, v48, v49
    v_mul_f32 v50, v48, v50
    v_mul_f32 v51, v48, v51
    v_cvt_pk_bf16_f32 v41, v48, v49
    v_cvt_pk_bf16_f32 v42, v50, v51
    v_bitop3_b32 v43, v40, v41, v42 bitop3:0x96
    v_xor_b32 v43, s63, v43
    v_or_b32 v27, 0x2b000000, v27
    v_lshl_or_b32 v44, v7, 10, v27
    v_and_b32 v48, 0xffff0000, v19
    v_and_b32 v49, 0xffff0000, v16
    v_lshlrev_b32 v50, 16, v17
    v_and_b32 v51, 0xffff0000, v17
    v_mul_f32 v49, v48, v49
    v_mul_f32 v50, v48, v50
    v_mul_f32 v51, v48, v51
    v_cvt_pk_bf16_f32 v45, v48, v49
    v_cvt_pk_bf16_f32 v46, v50, v51
    v_bitop3_b32 v47, v44, v45, v46 bitop3:0x96
    v_xor_b32 v47, s63, v47
K1_b4:
    s_mov_b64 exec, s[48:49]
    s_waitcnt lgkmcnt(0)
    s_barrier
    s_cmp_eq_u64 s[50:51], 0
    s_cbranch_scc1 K1_b5
    v_mbcnt_lo_u32_b32 v52, -1, 0
    v_mbcnt_hi_u32_b32 v52, -1, v52
    v_lshlrev_b32 v53, 4, v52
    ds_read_b128 v[56:59], v53 offset:32768
    s_waitcnt lgkmcnt(0)
    v_add_u32 v61, v56, v57
    v_add_u32 v62, v61, v58
    v_add_u32 v63, v62, v59
    v_mov_b32 v54, v63
    s_nop 1
    v_add_u32_dpp v54, v54, v54 row_shr:1 row_mask:0xf bank_mask:0xf bound_ctrl:0
    s_nop 1
    v_add_u32_dpp v54, v54, v54 row_shr:2 row_mask:0xf bank_mask:0xf bound_ctrl:0
    s_nop 1
    v_add_u32_dpp v54, v54, v54 row_shr:4 row_mask:0xf bank_mask:0xf bound_ctrl:0
    s_nop 1
    v_add_u32_dpp v54, v54, v54 row_shr:8 row_mask:0xf bank_mask:0xf bound_ctrl:0
    s_nop 1
    v_add_u32_dpp v54, v54, v54 row_bcast:15 row_mask:0xa bank_mask:0xf
    s_nop 1
    v_add_u32_dpp v54, v54, v54 row_bcast:31 row_mask:0xc bank_mask:0xf
    v_sub_u32 v64, v54, v63
    v_add_u32 v65, v64, v56
    v_add_u32 v66, v64, v61
    v_add_u32 v67, v64, v62
    ds_write_b128 v53, v[64:67] offset:33792
    v_readfirstlane_b32 s52, v0
    v_lshl_or_b32 v68, v56, 16, v64
    v_lshl_or_b32 v69, v57, 16, v65
    v_lshl_or_b32 v70, v58, 16, v66
    v_lshl_or_b32 v71, v59, 16, v67
    s_cmp_lg_u32 s52, 0
    s_cbranch_scc1 K1_notab
    v_or_b32 v8, 0xa0005000, v68
    v_xor_b32 v9, s63, v8
    v_or_b32 v10, 0xa0005000, v69
    v_xor_b32 v11, s63, v10
    v_or_b32 v12, 0xa0005000, v70
    v_xor_b32 v13, s63, v12
    v_or_b32 v14, 0xa0005000, v71
    v_xor_b32 v15, s63, v14
    s_lshl_b32 s53, s2, 11
    buffer_store_dwordx4 v[8:11], v53, s[40:43], s53 offen sc1
    buffer_store_dwordx4 v[12:15], v53, s[40:43], s53 offen offset:1024 sc1
K1_notab:
    s_mov_b64 exec, s[50:51]
    s_waitcnt lgkmcnt(0)
    ds_read_b32 v56, v20 offset:33792
    ds_read_b32 v57, v21 offset:33792
    ds_read_b32 v58, v22 offset:33792
    ds_read_b32 v59, v23 offset:33792
    s_waitcnt lgkmcnt(0)
    v_add_lshl_u32 v56, v56, v28, 4
    ds_write_b128 v56, v[32:35]
    v_add_lshl_u32 v57, v57, v29, 4
    ds_write_b128 v57, v[36:39]
    v_add_lshl_u32 v58, v58, v30, 4
    ds_write_b128 v58, v[40:43]
    v_add_lshl_u32 v59, v59, v31, 4
    ds_write_b128 v59, v[44:47]
K1_b5:
    s_mov_b64 exec, s[48:49]
    s_waitcnt lgkmcnt(0)
    s_barrier
    v_lshlrev_b32 v1, 4, v0
    s_mul_i32 s53, s2, 32768
    s_add_u32 s53, s53, 491776
    ds_read_b128 v[4:7], v1
    ds_read_b128 v[8:11], v1 offset:10240
    ds_read_b128 v[12:15], v1 offset:20480
    ds_read_b128 v[16:19], v1 offset:30720
    v_add_u32 v2, 10240, v1
    v_add_u32 v3, 20480, v1
    v_add_u32 v20, 30720, v1
    v_cmp_gt_u32 vcc, 80, v0
    s_waitcnt lgkmcnt(3)
    buffer_store_dwordx4 v[4:7], v1, s[40:43], s53 offen sc1
    s_waitcnt lgkmcnt(2)
    buffer_store_dwordx4 v[8:11], v2, s[40:43], s53 offen sc1
    s_waitcnt lgkmcnt(1)
    buffer_store_dwordx4 v[12:15], v3, s[40:43], s53 offen sc1
    s_and_saveexec_b64 s[22:23], vcc
    s_cbranch_execz K1_pend
    s_waitcnt lgkmcnt(0)
    buffer_store_dwordx4 v[16:19], v20, s[40:43], s53 offen sc1
K1_pend:
    s_mov_b64 exec, -1
    s_waitcnt lgkmcnt(0)
    s_barrier
    ds_write_b128 v83, v[116:119] offset:6144
    ds_write_b128 v83, v[116:119] offset:7168
    ds_write_b128 v83, v[116:119] offset:8192
    ds_write_b128 v83, v[116:119] offset:9216
    ds_write_b128 v83, v[116:119] offset:10240
    ds_write_b128 v83, v[116:119] offset:11264
    ds_write_b32 v84, v86 offset:0
    ds_write_b32 v84, v86 offset:256
    ds_write_b32 v85, v116
    s_mov_b32 s22, s65
    s_mov_b32 s50, 1024
    s_mov_b32 s51, s67
    s_mov_b32 s52, s66
    v_mov_b32 v56, v76
    v_mov_b32 v58, v77
    v_mov_b32 v59, v78
    v_mov_b32 v60, v79
    v_mov_b32 v28, v80
    v_mov_b32 v4, v81
    v_xor_b32 v5, 32, v81
    v_xor_b32 v6, 64, v81
    v_xor_b32 v7, 96, v81
    v_mov_b32 v2, v82
    v_xor_b32 v3, 64, v82
    s_branch FU_go
K1_pfw:
    s_mov_b64 exec, s[48:49]
    s_mul_i32 s53, s67, 192
    s_sub_u32 s53, s53, 512
    v_add_u32 v100, s53, v0
    v_lshlrev_b32 v100, 10, v100
    v_cmp_gt_u32 vcc, 576, v0
    v_mov_b32 v99, 1073741824
    s_nop 0
    v_cndmask_b32 v99, v99, v100, vcc
    s_mov_b32 s53, 0
    buffer_load_dword v101, v100, s[8:11], s53 offen offset:384
    s_mov_b32 s53, 131072
    buffer_load_dword v102, v99, s[8:11], s53 offen offset:384
    s_waitcnt vmcnt(2)
    v_readfirstlane_b32 s63, v73
    s_mul_i32 s63, s63, 1664525
    s_add_u32 s63, s63, 1013904221
    s_or_b32 s63, s63, 1
    s_branch K1_b4
K1_helper:
    s_sub_u32 s22, s2, 160
    v_lshrrev_b32 v1, 6, v0
    v_and_b32 v2, 63, v0
    s_mul_i32 s23, s22, 640
    v_add_u32 v3, s23, v0
    v_lshlrev_b32 v3, 7, v3
    v_readfirstlane_b32 s44, v1
    s_lshr_b32 s23, s22, 3
    s_mul_i32 s23, s23, 625
    v_add_u32 v4, s23, v0
    v_lshlrev_b32 v4, 10, v4
    s_waitcnt lgkmcnt(0)
    s_mov_b32 s24, s4
    s_mov_b32 s25, s5
    s_mov_b32 s26, 10240000
    s_mov_b32 s27, 0x20000
    s_mov_b32 s28, s14
    s_mov_b32 s29, s15
    s_mov_b32 s30, 1280
    s_mov_b32 s31, 0x20000
    s_mov_b32 s32, s16
    s_mov_b32 s33, s17
    s_mov_b32 s34, 65536
    s_mov_b32 s35, 0x20000
    s_mov_b32 s36, s18
    s_mov_b32 s37, s19
    s_mov_b32 s38, 98304
    s_mov_b32 s39, 0x20000
    s_mov_b32 s40, s20
    s_mov_b32 s41, s21
    s_mov_b32 s42, 5734656
    s_mov_b32 s43, 0x20000
    s_mul_i32 s45, s22, 10
    s_add_u32 s45, s45, s44
    s_and_b32 s46, s45, 1
    s_lshr_b32 s47, s45, 1
    s_mul_i32 s48, s47, 52429
    s_lshr_b32 s48, s48, 18
    s_mul_i32 s49, s48, 5
    s_sub_u32 s49, s47, s49
    s_and_b32 s50, s48, 7
    s_lshr_b32 s51, s48, 3
    s_lshl_b32 s52, s51, 6
    s_lshl_b32 s53, s46, 5
    s_add_u32 s52, s52, s53
    v_lshrrev_b32 v5, 4, v2
    v_and_b32 v6, 15, v2
    v_lshlrev_b32 v7, 10, v5
    v_lshl_add_u32 v7, v6, 1, v7
    v_lshlrev_b32 v8, 3, v5
    s_lshl_b32 s53, s49, 7
    s_add_u32 s53, s53, s52
    s_lshl_b32 s53, s53, 1
    buffer_load_dwordx2 v[10:11], v8, s[28:31], s53 offen
    buffer_load_dwordx2 v[12:13], v8, s[28:31], s53 offen offset:32
    s_cmp_ge_u32 s49, 2
    s_cbranch_scc1 K1_w1
    s_sub_u32 s54, s49, 0
    s_lshl_b32 s54, s54, 7
    s_add_u32 s54, s54, s52
    s_lshl_b32 s54, s54, 8
    s_lshl_b32 s55, s50, 5
    s_add_u32 s54, s54, s55
    s_add_u32 s55, s54, 4096
    buffer_load_ushort v16, v7, s[32:35], s54 offen offset:0
    buffer_load_ushort v17, v7, s[32:35], s54 offen offset:256
    buffer_load_ushort v18, v7, s[32:35], s54 offen offset:512
    buffer_load_ushort v19, v7, s[32:35], s54 offen offset:768
    buffer_load_ushort v20, v7, s[32:35], s55 offen offset:0
    buffer_load_ushort v21, v7, s[32:35], s55 offen offset:256
    buffer_load_ushort v22, v7, s[32:35], s55 offen offset:512
    buffer_load_ushort v23, v7, s[32:35], s55 offen offset:768
    s_branch K1_wj
K1_w1:
    s_sub_u32 s54, s49, 2
    s_lshl_b32 s54, s54, 7
    s_add_u32 s54, s54, s52
    s_lshl_b32 s54, s54, 8
    s_lshl_b32 s55, s50, 5
    s_add_u32 s54, s54, s55
    s_add_u32 s55, s54, 4096
    buffer_load_ushort v16, v7, s[36:39], s54 offen offset:0
    buffer_load_ushort v17, v7, s[36:39], s54 offen offset:256
    buffer_load_ushort v18, v7, s[36:39], s54 offen offset:512
    buffer_load_ushort v19, v7, s[36:39], s54 offen offset:768
    buffer_load_ushort v20, v7, s[36:39], s55 offen offset:0
    buffer_load_ushort v21, v7, s[36:39], s55 offen offset:256
    buffer_load_ushort v22, v7, s[36:39], s55 offen offset:512
    buffer_load_ushort v23, v7, s[36:39], s55 offen offset:768
K1_wj:
    s_waitcnt vmcnt(0)
    v_lshlrev_b32 v24, 16, v10
    v_lshlrev_b32 v16, 16, v16
    v_mul_f32 v16, v24, v16
    v_and_b32 v24, 0xffff0000, v10
    v_lshlrev_b32 v17, 16, v17
    v_mul_f32 v17, v24, v17
    v_lshlrev_b32 v24, 16, v11
    v_lshlrev_b32 v18, 16, v18
    v_mul_f32 v18, v24, v18
    v_and_b32 v24, 0xffff0000, v11
    v_lshlrev_b32 v19, 16, v19
    v_mul_f32 v19, v24, v19
    v_lshlrev_b32 v24, 16, v12
    v_lshlrev_b32 v20, 16, v20
    v_mul_f32 v20, v24, v20
    v_and_b32 v24, 0xffff0000, v12
    v_lshlrev_b32 v21, 16, v21
    v_mul_f32 v21, v24, v21
    v_lshlrev_b32 v24, 16, v13
    v_lshlrev_b32 v22, 16, v22
    v_mul_f32 v22, v24, v22
    v_and_b32 v24, 0xffff0000, v13
    v_lshlrev_b32 v23, 16, v23
    v_mul_f32 v23, v24, v23
    v_cvt_pk_bf16_f32 v40, v16, v17
    v_cvt_pk_bf16_f32 v41, v18, v19
    v_cvt_pk_bf16_f32 v42, v20, v21
    v_cvt_pk_bf16_f32 v43, v22, v23
    s_lshl_b32 s54, s45, 10
    s_add_u32 s54, s54, 327680
    v_lshlrev_b32 v9, 4, v2
    buffer_store_dwordx4 v[40:43], v9, s[40:43], s54 offen sc1
    s_waitcnt vmcnt(0)
    s_barrier
    s_cmp_lg_u32 s44, 0
    s_cbranch_scc1 K1_hnf
    s_lshl_b32 s54, s22, 2
    v_mov_b32 v10, s54
    v_mov_b32 v11, 1
    s_mov_b64 exec, 1
    global_store_dword v10, v11, s[58:59] sc1
    s_mov_b64 exec, -1
K1_hnf:
    s_getreg_b32 s23, hwreg(HW_REG_HW_ID, 8, 8)
    s_lshr_b32 s54, s23, 4
    s_and_b32 s54, s54, 6
    s_and_b32 s23, s23, 1
    s_or_b32 s23, s23, s54
    s_lshr_b32 s54, s2, 6
    s_lshl_b32 s54, s54, 3
    s_or_b32 s23, s23, s54
    s_lshr_b32 s54, s2, 3
    s_cmp_ge_u32 s2, 192
    s_cselect_b32 s23, s54, s23
    s_mul_i32 s23, s23, 192
    v_add_u32 v3, s23, v0
    v_lshlrev_b32 v3, 10, v3
    v_mov_b32 v5, 1073741824
    v_cmp_gt_u32 vcc, 0xc0, v0
    s_nop 1
    v_cndmask_b32 v3, v5, v3, vcc
    buffer_load_dword v30, v3, s[24:27], 0 offen offset:384
    s_branch FU_join
FU_idle:
    s_load_dwordx2 s[24:25], s[0:1], 0
    s_mov_b32 s26, 10240000
    s_mov_b32 s27, 0x20000
    v_mov_b32 v5, 1073741824
    s_getreg_b32 s23, hwreg(HW_REG_HW_ID, 8, 8)
    s_lshr_b32 s22, s23, 4
    s_and_b32 s22, s22, 6
    s_and_b32 s23, s23, 1
    s_or_b32 s23, s23, s22
    s_lshr_b32 s22, s2, 6
    s_lshl_b32 s22, s22, 3
    s_or_b32 s23, s23, s22
    s_lshr_b32 s22, s2, 3
    s_cmp_ge_u32 s2, 192
    s_cselect_b32 s23, s22, s23
    s_mul_i32 s23, s23, 192
    v_add_u32 v6, s23, v0
    v_lshlrev_b32 v6, 10, v6
    v_cmp_gt_u32 vcc, 0xc0, v0
    s_nop 1
    v_cndmask_b32 v6, v5, v6, vcc
    s_sub_u32 s23, s2, 192
    s_lshr_b32 s23, s23, 3
    s_mul_i32 s23, s23, 771
    s_add_u32 s23, s23, 4608
    v_add_u32 v3, s23, v0
    v_lshlrev_b32 v3, 10, v3
    v_cmp_gt_u32 vcc, 0x83, v0
    s_nop 1
    v_cndmask_b32 v4, v5, v3, vcc
    s_waitcnt lgkmcnt(0)
    s_cmp_ge_u32 s2, 192
    s_cbranch_scc1 FU_idl2
    buffer_load_dword v29, v6, s[24:27], 0 offen offset:384
    s_branch FU_join
FU_idl2:
    s_mov_b32 s23, 0
    buffer_load_dword v30, v3, s[24:27], s23 offen offset:384
    s_mov_b32 s23, 655360
    buffer_load_dword v31, v4, s[24:27], s23 offen offset:384
FU_join:
    s_load_dwordx2 s[58:59], s[0:1], 80
    s_mov_b32 s54, 1
    s_load_dwordx2 s[8:9], s[0:1], 0
    s_load_dwordx2 s[12:13], s[0:1], 88
    s_load_dwordx2 s[16:17], s[0:1], 72
    v_lshrrev_b32 v1, 6, v0
    s_and_b32 s37, s2, 7
    s_lshr_b32 s51, s2, 3
    s_mul_i32 s52, s37, 31
    s_min_u32 s37, s37, 2
    s_add_u32 s52, s52, s37
    s_add_u32 s52, s52, s51
    s_getreg_b32 s51, hwreg(HW_REG_HW_ID, 8, 8)
    s_lshr_b32 s37, s51, 4
    s_and_b32 s37, s37, 6
    s_and_b32 s51, s51, 1
    s_or_b32 s51, s51, s37
    s_lshr_b32 s37, s2, 6
    s_lshl_b32 s37, s37, 3
    s_or_b32 s51, s51, s37
    s_lshr_b32 s37, s2, 3
    s_cmp_ge_u32 s2, 192
    s_cselect_b32 s51, s37, s51
    v_readfirstlane_b32 s20, v1
    s_mov_b32 s50, 1024
    s_mov_b32 s35, 0
    s_mov_b32 s34, 0
    s_mov_b32 s36, 0
    s_mov_b32 s10, 10240000
    s_mov_b32 s11, 0x20000
    s_mov_b32 s14, 5734656
    s_mov_b32 s15, 0x20000
    s_mov_b32 s18, 10240000
    s_mov_b32 s19, 0x20000
    v_mov_b32 v116, 0
    v_mov_b32 v117, 0
    v_mov_b32 v118, 0
    v_mov_b32 v119, 0
    v_mov_b32 v120, 0
    v_mov_b32 v121, 0
    v_mov_b32 v122, 0
    v_mov_b32 v123, 0
    v_mov_b32 v124, 0
    v_mov_b32 v125, 0
    v_mov_b32 v126, 0
    v_mov_b32 v127, 0
    v_mov_b32 v128, 0
    v_mov_b32 v129, 0
    v_mov_b32 v130, 0
    v_mov_b32 v131, 0
    v_mov_b32 v132, 0
    v_mov_b32 v133, 0
    v_mov_b32 v134, 0
    v_mov_b32 v135, 0
    v_mov_b32 v136, 0
    v_mov_b32 v137, 0
    v_mov_b32 v138, 0
    v_mov_b32 v139, 0
    v_mov_b32 v140, 0
    v_mov_b32 v141, 0
    v_mov_b32 v142, 0
    v_mov_b32 v143, 0
    v_mov_b32 v144, 0
    v_mov_b32 v145, 0
    v_mov_b32 v146, 0
    v_mov_b32 v147, 0
    v_mov_b32 v148, 0
    v_mov_b32 v149, 0
    v_mov_b32 v150, 0
    v_mov_b32 v151, 0
    v_mov_b32 v152, 0
    v_mov_b32 v153, 0
    v_mov_b32 v154, 0
    v_mov_b32 v155, 0
    v_mov_b32 v156, 0
    v_mov_b32 v157, 0
    v_mov_b32 v158, 0
    v_mov_b32 v159, 0
    v_mov_b32 v160, 0
    v_mov_b32 v161, 0
    v_mov_b32 v162, 0
    v_mov_b32 v163, 0
    s_mul_i32 s22, s20, 12288
    s_mul_i32 s29, s20, 10240
    s_add_u32 s29, s29, 327680
    s_waitcnt lgkmcnt(0)
K2_round:
    v_mbcnt_lo_u32_b32 v56, -1, 0
    v_mbcnt_hi_u32_b32 v56, -1, v56
    s_lshl_b32 s37, s20, 6
    v_add_u32 v57, s37, v56
    v_lshrrev_b32 v58, 2, v57
    v_lshlrev_b32 v65, 11, v58
    s_lshl_b32 s37, s52, 2
    v_mov_b32 v60, v65
    v_and_b32 v59, 3, v57
    v_mov_b32 v20, 0
    v_mov_b32 v21, 0
    v_mov_b32 v22, 0
    v_mov_b32 v23, 0
    v_lshlrev_b32 v66, 4, v56
    v_add_u32 v66, s22, v66
    ds_write_b128 v66, v[20:23] offset:6144
    ds_write_b128 v66, v[20:23] offset:7168
    ds_write_b128 v66, v[20:23] offset:8192
    ds_write_b128 v66, v[20:23] offset:9216
    ds_write_b128 v66, v[20:23] offset:10240
    ds_write_b128 v66, v[20:23] offset:11264
    s_mul_i32 s37, s20, 512
    s_add_u32 s37, s37, 143424
    v_lshlrev_b32 v24, 2, v56
    v_add_u32 v24, s37, v24
    v_mov_b32 v25, -1
    ds_write_b32 v24, v25 offset:0
    ds_write_b32 v24, v25 offset:256
    v_and_b32 v26, 15, v56
    v_lshlrev_b32 v26, 2, v26
    v_add_u32 v26, 151104, v26
    ds_write_b32 v26, v20
    v_and_b32 v67, 15, v56
    v_lshrrev_b32 v68, 4, v56
    v_lshrrev_b32 v69, 2, v67
    v_and_b32 v70, 3, v56
    v_lshl_add_u32 v65, v68, 3, v69
    v_lshlrev_b32 v65, 7, v65
    v_lshl_add_u32 v65, v70, 3, v65
    v_add_u32 v65, s22, v65
    v_lshrrev_b32 v66, 1, v69
    v_and_b32 v27, 1, v68
    v_lshl_add_u32 v66, v27, 1, v66
    v_lshl_add_u32 v4, v66, 5, v65
    v_xor_b32 v5, 32, v4
    v_xor_b32 v6, 64, v4
    v_xor_b32 v7, 96, v4
    v_lshrrev_b32 v65, 3, v56
    v_lshlrev_b32 v65, 2, v65
    v_add_u32 v28, s37, v65
    v_and_b32 v65, 7, v56
    v_and_b32 v66, 1, v68
    v_lshlrev_b32 v66, 1, v66
    v_xor_b32 v65, v65, v66
    v_lshlrev_b32 v2, 4, v65
    v_xor_b32 v3, 64, v2
    s_lshl_b32 s38, s20, 2
    v_add_u32 v65, s38, v69
    v_and_b32 v66, 8, v65
    v_lshrrev_b32 v66, 2, v66
    v_xor_b32 v66, v66, v68
    v_lshlrev_b32 v65, 6, v65
    v_lshl_add_u32 v65, v66, 4, v65
    v_mul_u32_u24 v66, 5136, v70
    v_add_u32 v65, v65, v66
    v_add_u32 v164, 122880, v65
    v_and_b32 v66, 8, v67
    v_lshrrev_b32 v66, 2, v66
    v_xor_b32 v66, v66, v68
    v_lshlrev_b32 v65, 6, v67
    v_lshl_add_u32 v65, v66, 4, v65
    v_add_u32 v165, 122880, v65
    v_lshlrev_b32 v75, 8, v68
    v_lshl_add_u32 v75, v67, 3, v75
    v_add_u32 v75, s22, v75
    s_cmp_eq_u32 s54, 0
    s_cbranch_scc1 FU_bar
    s_cmp_lg_u32 s20, 1
    s_cbranch_scc1 FU_bar
    s_mov_b64 exec, 1
    s_cmp_lt_u32 s2, 160
    s_cbranch_scc1 FU_have
    s_mov_b32 s38, 0
    v_mov_b32 v66, 0
FU_poll:
    global_load_dword v72, v66, s[58:59] offset:128 sc1
    s_add_u32 s38, s38, 1
    s_waitcnt vmcnt(0)
    v_readfirstlane_b32 s63, v72
    s_cmp_lg_u32 s63, 0
    s_cbranch_scc1 FU_have
    s_sleep 4
    s_cmp_lt_u32 s38, 0x40000
    s_cbranch_scc1 FU_poll
FU_have:
    v_mov_b32 v66, 151168
    v_mov_b32 v72, s63
    ds_write_b32 v66, v72
    s_mov_b64 exec, -1
FU_bar:
    s_waitcnt lgkmcnt(0)
    s_barrier
    s_cmp_eq_u32 s54, 0
    s_cbranch_scc1 FU_go
    s_mov_b32 s54, 0
    v_mov_b32 v65, 151168
    ds_read_b32 v65, v65
FU_n0:
    s_waitcnt lgkmcnt(0)
    v_readfirstlane_b32 s63, v65
FU_go:
    s_lshr_b32 s37, s52, 2
    s_lshl_b32 s37, s37, 4
    s_and_b32 s38, s52, 1
    s_lshl_b32 s38, s38, 3
    s_add_u32 s37, s37, s38
    s_and_b32 s38, s52, 2
    s_lshl_b32 s38, s38, 9
    s_add_u32 s37, s37, s38
    v_mov_b32 v71, v60
    s_mov_b32 s38, 0
    v_mov_b32 v73, 0
    v_and_b32 v74, 15, v56
    v_lshlrev_b32 v74, 2, v74
FU_tpoll:
    buffer_load_dwordx2 v[60:61], v71, s[12:15], s37 offen sc1
    s_cmp_lg_u32 s20, 9
    s_cbranch_scc1 FU_tnb
    global_load_dword v73, v74, s[58:59] offset:0 sc1
FU_tnb:
    s_add_u32 s38, s38, 1
    s_waitcnt vmcnt(0)
    v_bitop3_b32 v65, v60, v61, s63 bitop3:0x96
    v_and_b32 v66, 0xf000f000, v60
    v_xor_b32 v66, 0xa0005000, v66
    v_or_b32 v65, v65, v66
    v_cmp_ne_u32 vcc, 0, v65
    s_and_b64 exec, exec, vcc
    s_cbranch_execz FU_tok
    s_sleep 2
    s_cmp_lt_u32 s38, 0x40000
    s_cbranch_scc1 FU_tpoll
FU_tok:
    s_mov_b64 exec, -1
    s_waitcnt vmcnt(0)
    v_bfe_u32 v64, v60, 16, 12
    v_and_b32 v61, 0xfff, v60
    v_mul_u32_u24 v65, 32768, v58
    v_lshl_add_u32 v61, v61, 4, v65
    s_cmp_eq_u32 s35, 0
    s_cbranch_scc0 K2_slowwin
    v_mov_b32 v62, v59
    v_mov_b32 v63, v64
    s_branch K2_winok
K2_slowwin:
    v_lshlrev_b32 v65, 2, v58
    v_add_u32 v65, 151168, v65
    ds_read_b32 v65, v65
    s_waitcnt lgkmcnt(0)
    v_sub_u32 v65, s34, v65
    v_add_u32 v66, 192, v65
    v_med3_i32 v65, v65, 0, v64
    v_med3_i32 v63, v66, 0, v64
    v_add_u32 v62, v65, v59
K2_winok:
    s_mov_b32 s39, 1
K2_bin:
    v_add_u32 v65, 0, v62
    v_cmp_lt_u32 vcc, v65, v63
    v_lshl_add_u32 v65, v65, 4, v61
    s_mov_b64 s[40:41], vcc
    v_mov_b32 v66, 1073741824
    v_cndmask_b32 v20, v66, v65, vcc
    v_add_u32 v65, 4, v62
    v_cmp_lt_u32 vcc, v65, v63
    v_lshl_add_u32 v65, v65, 4, v61
    s_mov_b64 s[42:43], vcc
    v_mov_b32 v66, 1073741824
    v_cndmask_b32 v21, v66, v65, vcc
    v_add_u32 v65, 8, v62
    v_cmp_lt_u32 vcc, v65, v63
    v_lshl_add_u32 v65, v65, 4, v61
    s_mov_b64 s[44:45], vcc
    v_mov_b32 v66, 1073741824
    v_cndmask_b32 v22, v66, v65, vcc
    v_add_u32 v65, 12, v62
    v_cmp_lt_u32 vcc, v65, v63
    v_lshl_add_u32 v65, v65, 4, v61
    s_mov_b64 s[46:47], vcc
    v_mov_b32 v66, 1073741824
    v_cndmask_b32 v23, v66, v65, vcc
    v_add_u32 v65, 16, v62
    v_cmp_lt_u32 vcc, v65, v63
    v_lshl_add_u32 v65, v65, 4, v61
    s_mov_b64 s[48:49], vcc
    v_mov_b32 v66, 1073741824
    v_cndmask_b32 v24, v66, v65, vcc
    s_mov_b32 s37, 491776
    buffer_load_dwordx4 v[36:39], v20, s[12:15], s37 offen sc1
    buffer_load_dwordx4 v[40:43], v21, s[12:15], s37 offen sc1
    buffer_load_dwordx4 v[44:47], v22, s[12:15], s37 offen sc1
    buffer_load_dwordx4 v[48:51], v23, s[12:15], s37 offen sc1
    buffer_load_dwordx4 v[52:55], v24, s[12:15], s37 offen sc1
    s_cmp_eq_u32 s39, 0
    s_cbranch_scc1 K2_bin_w0
    s_mov_b32 s39, 0
    s_cmp_lg_u32 s20, 9
    s_cbranch_scc1 FU_bok
    s_mov_b32 s38, 0
FU_bpoll:
    v_cmp_ne_u32 vcc, 0, v73
    s_cmp_eq_u64 vcc, -1
    s_cbranch_scc1 FU_bok2
    global_load_dword v73, v74, s[58:59] offset:0 sc1
    s_add_u32 s38, s38, 1
    s_waitcnt vmcnt(0)
    s_cmp_lt_u32 s38, 0x40000
    s_cbranch_scc1 FU_bpoll
FU_bok2:
    s_cmp_lg_u32 s20, 9
    s_cbranch_scc1 K2_pfw0
    v_mbcnt_lo_u32_b32 v77, -1, 0
    v_mbcnt_hi_u32_b32 v77, -1, v77
    v_mov_b32 v78, s51
    v_mad_u32_u24 v78, v78, 21, v77
    v_cmp_gt_u32 vcc, 21, v77
    v_mov_b32 v79, 640
    s_nop 0
    v_cndmask_b32 v78, v79, v78, vcc
    v_cmp_gt_u32 vcc, 640, v78
    v_lshlrev_b32 v78, 7, v78
    v_add_u32 v78, 409600, v78
    v_mov_b32 v77, 1073741824
    v_cndmask_b32 v78, v77, v78, vcc
    buffer_load_dword v76, v78, s[12:15], 0 offen sc1
K2_pfw0:
FU_bok:
    s_waitcnt lgkmcnt(0)
    s_barrier
    s_cmp_ge_u32 s20, 8
    s_cbranch_scc1 K2_bin_w8
    s_add_u32 s53, s29, 81920
    v_mbcnt_lo_u32_b32 v1, -1, 0
    v_mbcnt_hi_u32_b32 v1, -1, v1
    v_lshlrev_b32 v1, 4, v1
    buffer_load_dwordx4 v[76:79], v1, s[12:15], s53 offen offset:0 sc1
    buffer_load_dwordx4 v[80:83], v1, s[12:15], s53 offen offset:1024 sc1
    buffer_load_dwordx4 v[84:87], v1, s[12:15], s53 offen offset:2048 sc1
    buffer_load_dwordx4 v[88:91], v1, s[12:15], s53 offen offset:3072 sc1
    s_add_u32 s53, s53, 4096
    buffer_load_dwordx4 v[92:95], v1, s[12:15], s53 offen offset:0 sc1
    buffer_load_dwordx4 v[96:99], v1, s[12:15], s53 offen offset:1024 sc1
    buffer_load_dwordx4 v[100:103], v1, s[12:15], s53 offen offset:2048 sc1
    buffer_load_dwordx4 v[104:107], v1, s[12:15], s53 offen offset:3072 sc1
    s_add_u32 s53, s53, 4096
    buffer_load_dwordx4 v[108:111], v1, s[12:15], s53 offen offset:0 sc1
    buffer_load_dwordx4 v[112:115], v1, s[12:15], s53 offen offset:1024 sc1
    s_waitcnt vmcnt(10)
    s_branch K2_bin_go
K2_bin_w8:
    s_waitcnt vmcnt(0)
    s_branch K2_bin_go
K2_bin_w0:
    s_waitcnt vmcnt(0)
K2_bin_go:
    s_mov_b32 s38, 0
K2_val:
    v_bitop3_b32 v65, v36, v37, v38 bitop3:0x96
    v_bitop3_b32 v65, v65, v39, s63 bitop3:0x96
    v_cmp_ne_u32_sdwa s[56:57], v36, 43 src0_sel:BYTE_3 src1_sel:DWORD
    v_cmp_ne_u32 vcc, 0, v65
    s_or_b64 vcc, vcc, s[56:57]
    s_and_b64 s[60:61], vcc, s[40:41]
    v_bitop3_b32 v65, v40, v41, v42 bitop3:0x96
    v_bitop3_b32 v65, v65, v43, s63 bitop3:0x96
    v_cmp_ne_u32_sdwa s[56:57], v40, 43 src0_sel:BYTE_3 src1_sel:DWORD
    v_cmp_ne_u32 vcc, 0, v65
    s_or_b64 vcc, vcc, s[56:57]
    s_and_b64 vcc, vcc, s[42:43]
    s_or_b64 s[60:61], s[60:61], vcc
    v_bitop3_b32 v65, v44, v45, v46 bitop3:0x96
    v_bitop3_b32 v65, v65, v47, s63 bitop3:0x96
    v_cmp_ne_u32_sdwa s[56:57], v44, 43 src0_sel:BYTE_3 src1_sel:DWORD
    v_cmp_ne_u32 vcc, 0, v65
    s_or_b64 vcc, vcc, s[56:57]
    s_and_b64 vcc, vcc, s[44:45]
    s_or_b64 s[60:61], s[60:61], vcc
    v_bitop3_b32 v65, v48, v49, v50 bitop3:0x96
    v_bitop3_b32 v65, v65, v51, s63 bitop3:0x96
    v_cmp_ne_u32_sdwa s[56:57], v48, 43 src0_sel:BYTE_3 src1_sel:DWORD
    v_cmp_ne_u32 vcc, 0, v65
    s_or_b64 vcc, vcc, s[56:57]
    s_and_b64 vcc, vcc, s[46:47]
    s_or_b64 s[60:61], s[60:61], vcc
    v_bitop3_b32 v65, v52, v53, v54 bitop3:0x96
    v_bitop3_b32 v65, v65, v55, s63 bitop3:0x96
    v_cmp_ne_u32_sdwa s[56:57], v52, 43 src0_sel:BYTE_3 src1_sel:DWORD
    v_cmp_ne_u32 vcc, 0, v65
    s_or_b64 vcc, vcc, s[56:57]
    s_and_b64 vcc, vcc, s[48:49]
    s_or_b64 s[60:61], s[60:61], vcc
    s_cmp_eq_u64 s[60:61], 0
    s_cbranch_scc1 K2_valok
    s_mov_b32 s37, 491776
    s_mov_b64 exec, s[60:61]
    buffer_load_dwordx4 v[36:39], v20, s[12:15], s37 offen sc1
    buffer_load_dwordx4 v[40:43], v21, s[12:15], s37 offen sc1
    buffer_load_dwordx4 v[44:47], v22, s[12:15], s37 offen sc1
    buffer_load_dwordx4 v[48:51], v23, s[12:15], s37 offen sc1
    buffer_load_dwordx4 v[52:55], v24, s[12:15], s37 offen sc1
    s_mov_b64 exec, -1
    s_add_u32 s38, s38, 1
    s_waitcnt vmcnt(0)
    s_cmp_lt_u32 s38, 0x40000
    s_cbranch_scc1 K2_val
K2_valok:
    v_mov_b32 v66, 1
    s_mov_b32 s38, 151104
    s_mov_b64 exec, s[40:41]
    s_cbranch_execz K2_ba_1
    v_and_or_b32 v65, v36, 60, s38
    ds_add_rtn_u32 v39, v65, v66
K2_ba_1:
    s_mov_b64 exec, s[42:43]
    s_cbranch_execz K2_ba_2
    v_and_or_b32 v65, v40, 60, s38
    ds_add_rtn_u32 v43, v65, v66
K2_ba_2:
    s_mov_b64 exec, s[44:45]
    s_cbranch_execz K2_ba_3
    v_and_or_b32 v65, v44, 60, s38
    ds_add_rtn_u32 v47, v65, v66
K2_ba_3:
    s_mov_b64 exec, s[46:47]
    s_cbranch_execz K2_ba_4
    v_and_or_b32 v65, v48, 60, s38
    ds_add_rtn_u32 v51, v65, v66
K2_ba_4:
    s_mov_b64 exec, s[48:49]
    s_cbranch_execz K2_ba_5
    v_and_or_b32 v65, v52, 60, s38
    ds_add_rtn_u32 v55, v65, v66
K2_ba_5:
    s_mov_b64 exec, -1
    s_waitcnt lgkmcnt(0)
    s_movk_i32 s38, 192
    s_mov_b64 exec, s[40:41]
    s_cbranch_execz K2_bw_6
    v_cmp_gt_u32 vcc, s38, v39
    s_and_b64 exec, exec, vcc
    v_bfe_u32 v65, v36, 2, 4
    v_and_b32 v30, 0xf0, v39
    v_lshlrev_b32 v66, 9, v65
    v_lshl_add_u32 v66, v30, 1, v66
    v_and_b32 v30, 7, v39
    v_lshl_add_u32 v66, v30, 2, v66
    v_bfe_u32 v30, v39, 3, 1
    v_lshl_add_u32 v66, v30, 1, v66
    v_mul_u32_u24 v65, 12288, v65
    v_lshl_add_u32 v65, v39, 5, v65
    v_and_b32 v39, 3, v36
    v_lshl_add_u32 v65, v39, 3, v65
    v_bfe_u32 v36, v36, 10, 14
    v_add_u32 v66, 143424, v66
    ds_write_b16 v66, v36
    v_add_u32 v65, 6144, v65
    ds_write2_b32 v65, v37, v38 offset0:0 offset1:1
K2_bw_6:
    s_mov_b64 exec, s[42:43]
    s_cbranch_execz K2_bw_7
    v_cmp_gt_u32 vcc, s38, v43
    s_and_b64 exec, exec, vcc
    v_bfe_u32 v65, v40, 2, 4
    v_and_b32 v30, 0xf0, v43
    v_lshlrev_b32 v66, 9, v65
    v_lshl_add_u32 v66, v30, 1, v66
    v_and_b32 v30, 7, v43
    v_lshl_add_u32 v66, v30, 2, v66
    v_bfe_u32 v30, v43, 3, 1
    v_lshl_add_u32 v66, v30, 1, v66
    v_mul_u32_u24 v65, 12288, v65
    v_lshl_add_u32 v65, v43, 5, v65
    v_and_b32 v43, 3, v40
    v_lshl_add_u32 v65, v43, 3, v65
    v_bfe_u32 v40, v40, 10, 14
    v_add_u32 v66, 143424, v66
    ds_write_b16 v66, v40
    v_add_u32 v65, 6144, v65
    ds_write2_b32 v65, v41, v42 offset0:0 offset1:1
K2_bw_7:
    s_mov_b64 exec, s[44:45]
    s_cbranch_execz K2_bw_8
    v_cmp_gt_u32 vcc, s38, v47
    s_and_b64 exec, exec, vcc
    v_bfe_u32 v65, v44, 2, 4
    v_and_b32 v30, 0xf0, v47
    v_lshlrev_b32 v66, 9, v65
    v_lshl_add_u32 v66, v30, 1, v66
    v_and_b32 v30, 7, v47
    v_lshl_add_u32 v66, v30, 2, v66
    v_bfe_u32 v30, v47, 3, 1
    v_lshl_add_u32 v66, v30, 1, v66
    v_mul_u32_u24 v65, 12288, v65
    v_lshl_add_u32 v65, v47, 5, v65
    v_and_b32 v47, 3, v44
    v_lshl_add_u32 v65, v47, 3, v65
    v_bfe_u32 v44, v44, 10, 14
    v_add_u32 v66, 143424, v66
    ds_write_b16 v66, v44
    v_add_u32 v65, 6144, v65
    ds_write2_b32 v65, v45, v46 offset0:0 offset1:1
K2_bw_8:
    s_mov_b64 exec, s[46:47]
    s_cbranch_execz K2_bw_9
    v_cmp_gt_u32 vcc, s38, v51
    s_and_b64 exec, exec, vcc
    v_bfe_u32 v65, v48, 2, 4
    v_and_b32 v30, 0xf0, v51
    v_lshlrev_b32 v66, 9, v65
    v_lshl_add_u32 v66, v30, 1, v66
    v_and_b32 v30, 7, v51
    v_lshl_add_u32 v66, v30, 2, v66
    v_bfe_u32 v30, v51, 3, 1
    v_lshl_add_u32 v66, v30, 1, v66
    v_mul_u32_u24 v65, 12288, v65
    v_lshl_add_u32 v65, v51, 5, v65
    v_and_b32 v51, 3, v48
    v_lshl_add_u32 v65, v51, 3, v65
    v_bfe_u32 v48, v48, 10, 14
    v_add_u32 v66, 143424, v66
    ds_write_b16 v66, v48
    v_add_u32 v65, 6144, v65
    ds_write2_b32 v65, v49, v50 offset0:0 offset1:1
K2_bw_9:
    s_mov_b64 exec, s[48:49]
    s_cbranch_execz K2_bw_10
    v_cmp_gt_u32 vcc, s38, v55
    s_and_b64 exec, exec, vcc
    v_bfe_u32 v65, v52, 2, 4
    v_and_b32 v30, 0xf0, v55
    v_lshlrev_b32 v66, 9, v65
    v_lshl_add_u32 v66, v30, 1, v66
    v_and_b32 v30, 7, v55
    v_lshl_add_u32 v66, v30, 2, v66
    v_bfe_u32 v30, v55, 3, 1
    v_lshl_add_u32 v66, v30, 1, v66
    v_mul_u32_u24 v65, 12288, v65
    v_lshl_add_u32 v65, v55, 5, v65
    v_and_b32 v55, 3, v52
    v_lshl_add_u32 v65, v55, 3, v65
    v_bfe_u32 v52, v52, 10, 14
    v_add_u32 v66, 143424, v66
    ds_write_b16 v66, v52
    v_add_u32 v65, 6144, v65
    ds_write2_b32 v65, v53, v54 offset0:0 offset1:1
K2_bw_10:
    s_mov_b64 exec, -1
    v_add_u32 v62, 20, v62
    v_cmp_lt_u32 vcc, v62, v63
    s_cbranch_vccnz K2_bin
    s_waitcnt lgkmcnt(0)
    s_barrier
    v_and_b32 v65, 15, v56
    v_lshlrev_b32 v65, 2, v65
    v_add_u32 v65, 151104, v65
    ds_read_b32 v65, v65
    ds_read_b32 v8, v28 offset:0
    ds_read_b32 v9, v28 offset:32
    ds_read_b32 v10, v28 offset:64
    ds_read_b32 v11, v28 offset:96
    ds_read_b32 v12, v28 offset:128
    ds_read_b32 v13, v28 offset:160
    ds_read_b32 v14, v28 offset:192
    ds_read_b32 v15, v28 offset:224
    ds_read_b32 v16, v28 offset:256
    ds_read_b32 v17, v28 offset:288
    ds_read_b32 v18, v28 offset:320
    ds_read_b32 v19, v28 offset:352
    s_waitcnt lgkmcnt(12)
    v_cmp_lt_u32 vcc, 192, v65
    v_readlane_b32 s21, v65, s20
    s_cbranch_vccnz K2_overflow
K2_nover:
    ds_read_b64_tr_b16 v[52:53], v75 offset:6144
    ds_read_b64_tr_b16 v[54:55], v75 offset:6272
    ds_read_b64_tr_b16 v[56:57], v75 offset:7168
    ds_read_b64_tr_b16 v[58:59], v75 offset:7296
    ds_read_b64_tr_b16 v[60:61], v75 offset:8192
    ds_read_b64_tr_b16 v[62:63], v75 offset:8320
    ds_read_b64_tr_b16 v[64:65], v75 offset:9216
    ds_read_b64_tr_b16 v[66:67], v75 offset:9344
    ds_read_b64_tr_b16 v[68:69], v75 offset:10240
    ds_read_b64_tr_b16 v[70:71], v75 offset:10368
    ds_read_b64_tr_b16 v[72:73], v75 offset:11264
    ds_read_b64_tr_b16 v[74:75], v75 offset:11392
    s_add_u32 s21, s21, 31
    s_lshr_b32 s21, s21, 5
    s_max_u32 s21, s21, 1
    s_mov_b32 s28, 0
    s_mov_b32 s24, 384
    s_waitcnt lgkmcnt(12)
    s_add_u32 m0, s22, 0
    v_mad_u32_u16 v0, v8, s50, v2 op_sel:[0,0,0,0]
    buffer_load_dwordx4 v0, s[8:11], s24 offen lds
    s_add_u32 m0, s22, 1024
    v_mad_u32_u16 v1, v8, s50, v3 op_sel:[1,0,0,0]
    buffer_load_dwordx4 v1, s[8:11], s24 offen lds
    s_add_u32 m0, s22, 2048
    v_mad_u32_u16 v0, v9, s50, v2 op_sel:[0,0,0,0]
    buffer_load_dwordx4 v0, s[8:11], s24 offen lds
    s_add_u32 m0, s22, 3072
    v_mad_u32_u16 v1, v9, s50, v3 op_sel:[1,0,0,0]
    buffer_load_dwordx4 v1, s[8:11], s24 offen lds
    s_waitcnt lgkmcnt(0)
    s_add_u32 m0, s22, 4096
    v_mad_u32_u16 v0, v10, s50, v2 op_sel:[0,0,0,0]
    buffer_load_dwordx4 v0, s[8:11], s24 offen lds
    s_add_u32 m0, s22, 5120
    v_mad_u32_u16 v1, v10, s50, v3 op_sel:[1,0,0,0]
    buffer_load_dwordx4 v1, s[8:11], s24 offen lds
    s_add_u32 m0, s22, 6144
    v_mad_u32_u16 v0, v11, s50, v2 op_sel:[0,0,0,0]
    buffer_load_dwordx4 v0, s[8:11], s24 offen lds
    s_add_u32 m0, s22, 7168
    v_mad_u32_u16 v1, v11, s50, v3 op_sel:[1,0,0,0]
    buffer_load_dwordx4 v1, s[8:11], s24 offen lds
    s_add_u32 m0, s22, 8192
    v_mad_u32_u16 v0, v12, s50, v2 op_sel:[0,0,0,0]
    buffer_load_dwordx4 v0, s[8:11], s24 offen lds
    s_add_u32 m0, s22, 9216
    v_mad_u32_u16 v1, v12, s50, v3 op_sel:[1,0,0,0]
    buffer_load_dwordx4 v1, s[8:11], s24 offen lds
    s_add_u32 m0, s22, 10240
    v_mad_u32_u16 v0, v13, s50, v2 op_sel:[0,0,0,0]
    buffer_load_dwordx4 v0, s[8:11], s24 offen lds
    s_add_u32 m0, s22, 11264
    v_mad_u32_u16 v1, v13, s50, v3 op_sel:[1,0,0,0]
    buffer_load_dwordx4 v1, s[8:11], s24 offen lds
K2_slice:
    s_cmp_eq_u32 s21, 4
    s_cbranch_scc1 K2_n4
    s_cmp_eq_u32 s21, 5
    s_cbranch_scc1 K2_n5
    s_cmp_eq_u32 s21, 3
    s_cbranch_scc1 K2_n3
    s_cmp_eq_u32 s21, 6
    s_cbranch_scc1 K2_n6
    s_cmp_eq_u32 s21, 2
    s_cbranch_scc1 K2_n2
K2_n1:
    s_waitcnt vmcnt(8)
    ds_read_b64_tr_b16 v[20:21], v4 offset:0
    ds_read_b64_tr_b16 v[22:23], v4 offset:512
    ds_read_b64_tr_b16 v[24:25], v5 offset:0
    ds_read_b64_tr_b16 v[26:27], v5 offset:512
    ds_read_b64_tr_b16 v[28:29], v6 offset:0
    ds_read_b64_tr_b16 v[30:31], v6 offset:512
    ds_read_b64_tr_b16 v[32:33], v7 offset:0
    ds_read_b64_tr_b16 v[34:35], v7 offset:512
    s_waitcnt lgkmcnt(6)
    v_mfma_f32_16x16x32_bf16 v[36:39], v[20:23], v[52:55], 0
    s_waitcnt lgkmcnt(4)
    v_mfma_f32_16x16x32_bf16 v[40:43], v[24:27], v[52:55], 0
    s_waitcnt lgkmcnt(2)
    v_mfma_f32_16x16x32_bf16 v[44:47], v[28:31], v[52:55], 0
    s_waitcnt lgkmcnt(0)
    v_mfma_f32_16x16x32_bf16 v[48:51], v[32:35], v[52:55], 0
    s_barrier
    s_branch K2_gap
K2_n2:
    s_waitcnt vmcnt(8)
    ds_read_b64_tr_b16 v[20:21], v4 offset:0
    ds_read_b64_tr_b16 v[22:23], v4 offset:512
    ds_read_b64_tr_b16 v[24:25], v5 offset:0
    ds_read_b64_tr_b16 v[26:27], v5 offset:512
    ds_read_b64_tr_b16 v[28:29], v6 offset:0
    ds_read_b64_tr_b16 v[30:31], v6 offset:512
    ds_read_b64_tr_b16 v[32:33], v7 offset:0
    ds_read_b64_tr_b16 v[34:35], v7 offset:512
    s_waitcnt lgkmcnt(6)
    v_mfma_f32_16x16x32_bf16 v[36:39], v[20:23], v[52:55], 0
    s_waitcnt lgkmcnt(4)
    v_mfma_f32_16x16x32_bf16 v[40:43], v[24:27], v[52:55], 0
    s_waitcnt lgkmcnt(2)
    v_mfma_f32_16x16x32_bf16 v[44:47], v[28:31], v[52:55], 0
    s_waitcnt lgkmcnt(0)
    v_mfma_f32_16x16x32_bf16 v[48:51], v[32:35], v[52:55], 0
    s_barrier
    s_waitcnt vmcnt(4)
    ds_read_b64_tr_b16 v[20:21], v4 offset:4096
    ds_read_b64_tr_b16 v[22:23], v4 offset:4608
    ds_read_b64_tr_b16 v[24:25], v5 offset:4096
    ds_read_b64_tr_b16 v[26:27], v5 offset:4608
    ds_read_b64_tr_b16 v[28:29], v6 offset:4096
    ds_read_b64_tr_b16 v[30:31], v6 offset:4608
    ds_read_b64_tr_b16 v[32:33], v7 offset:4096
    ds_read_b64_tr_b16 v[34:35], v7 offset:4608
    s_waitcnt lgkmcnt(6)
    v_mfma_f32_16x16x32_bf16 v[36:39], v[20:23], v[56:59], v[36:39]
    s_waitcnt lgkmcnt(4)
    v_mfma_f32_16x16x32_bf16 v[40:43], v[24:27], v[56:59], v[40:43]
    s_waitcnt lgkmcnt(2)
    v_mfma_f32_16x16x32_bf16 v[44:47], v[28:31], v[56:59], v[44:47]
    s_waitcnt lgkmcnt(0)
    v_mfma_f32_16x16x32_bf16 v[48:51], v[32:35], v[56:59], v[48:51]
    s_branch K2_gap
K2_n3:
    s_waitcnt vmcnt(8)
    ds_read_b64_tr_b16 v[20:21], v4 offset:0
    ds_read_b64_tr_b16 v[22:23], v4 offset:512
    ds_read_b64_tr_b16 v[24:25], v5 offset:0
    ds_read_b64_tr_b16 v[26:27], v5 offset:512
    ds_read_b64_tr_b16 v[28:29], v6 offset:0
    ds_read_b64_tr_b16 v[30:31], v6 offset:512
    ds_read_b64_tr_b16 v[32:33], v7 offset:0
    ds_read_b64_tr_b16 v[34:35], v7 offset:512
    s_waitcnt lgkmcnt(6)
    v_mfma_f32_16x16x32_bf16 v[36:39], v[20:23], v[52:55], 0
    s_waitcnt lgkmcnt(4)
    v_mfma_f32_16x16x32_bf16 v[40:43], v[24:27], v[52:55], 0
    s_waitcnt lgkmcnt(2)
    v_mfma_f32_16x16x32_bf16 v[44:47], v[28:31], v[52:55], 0
    s_waitcnt lgkmcnt(0)
    v_mfma_f32_16x16x32_bf16 v[48:51], v[32:35], v[52:55], 0
    s_barrier
    s_waitcnt vmcnt(4)
    ds_read_b64_tr_b16 v[20:21], v4 offset:4096
    ds_read_b64_tr_b16 v[22:23], v4 offset:4608
    ds_read_b64_tr_b16 v[24:25], v5 offset:4096
    ds_read_b64_tr_b16 v[26:27], v5 offset:4608
    ds_read_b64_tr_b16 v[28:29], v6 offset:4096
    ds_read_b64_tr_b16 v[30:31], v6 offset:4608
    ds_read_b64_tr_b16 v[32:33], v7 offset:4096
    ds_read_b64_tr_b16 v[34:35], v7 offset:4608
    s_waitcnt lgkmcnt(6)
    v_mfma_f32_16x16x32_bf16 v[36:39], v[20:23], v[56:59], v[36:39]
    s_waitcnt lgkmcnt(4)
    v_mfma_f32_16x16x32_bf16 v[40:43], v[24:27], v[56:59], v[40:43]
    s_waitcnt lgkmcnt(2)
    v_mfma_f32_16x16x32_bf16 v[44:47], v[28:31], v[56:59], v[44:47]
    s_waitcnt lgkmcnt(0)
    v_mfma_f32_16x16x32_bf16 v[48:51], v[32:35], v[56:59], v[48:51]
    s_waitcnt vmcnt(0)
    ds_read_b64_tr_b16 v[20:21], v4 offset:8192
    ds_read_b64_tr_b16 v[22:23], v4 offset:8704
    ds_read_b64_tr_b16 v[24:25], v5 offset:8192
    ds_read_b64_tr_b16 v[26:27], v5 offset:8704
    ds_read_b64_tr_b16 v[28:29], v6 offset:8192
    ds_read_b64_tr_b16 v[30:31], v6 offset:8704
    ds_read_b64_tr_b16 v[32:33], v7 offset:8192
    ds_read_b64_tr_b16 v[34:35], v7 offset:8704
    s_waitcnt lgkmcnt(6)
    v_mfma_f32_16x16x32_bf16 v[36:39], v[20:23], v[60:63], v[36:39]
    s_waitcnt lgkmcnt(4)
    v_mfma_f32_16x16x32_bf16 v[40:43], v[24:27], v[60:63], v[40:43]
    s_waitcnt lgkmcnt(2)
    v_mfma_f32_16x16x32_bf16 v[44:47], v[28:31], v[60:63], v[44:47]
    s_waitcnt lgkmcnt(0)
    v_mfma_f32_16x16x32_bf16 v[48:51], v[32:35], v[60:63], v[48:51]
    s_branch K2_gap
K2_n6:
    s_waitcnt vmcnt(8)
    ds_read_b64_tr_b16 v[20:21], v4 offset:0
    ds_read_b64_tr_b16 v[22:23], v4 offset:512
    ds_read_b64_tr_b16 v[24:25], v5 offset:0
    ds_read_b64_tr_b16 v[26:27], v5 offset:512
    ds_read_b64_tr_b16 v[28:29], v6 offset:0
    ds_read_b64_tr_b16 v[30:31], v6 offset:512
    ds_read_b64_tr_b16 v[32:33], v7 offset:0
    ds_read_b64_tr_b16 v[34:35], v7 offset:512
    s_waitcnt lgkmcnt(6)
    v_mfma_f32_16x16x32_bf16 v[36:39], v[20:23], v[52:55], 0
    s_waitcnt lgkmcnt(4)
    v_mfma_f32_16x16x32_bf16 v[40:43], v[24:27], v[52:55], 0
    s_waitcnt lgkmcnt(2)
    v_mfma_f32_16x16x32_bf16 v[44:47], v[28:31], v[52:55], 0
    s_waitcnt lgkmcnt(0)
    v_mfma_f32_16x16x32_bf16 v[48:51], v[32:35], v[52:55], 0
    s_add_u32 m0, s22, 0
    v_mad_u32_u16 v0, v14, s50, v2 op_sel:[0,0,0,0]
    buffer_load_dwordx4 v0, s[8:11], s24 offen lds
    s_add_u32 m0, s22, 1024
    v_mad_u32_u16 v1, v14, s50, v3 op_sel:[1,0,0,0]
    buffer_load_dwordx4 v1, s[8:11], s24 offen lds
    s_add_u32 m0, s22, 2048
    v_mad_u32_u16 v0, v15, s50, v2 op_sel:[0,0,0,0]
    buffer_load_dwordx4 v0, s[8:11], s24 offen lds
    s_add_u32 m0, s22, 3072
    v_mad_u32_u16 v1, v15, s50, v3 op_sel:[1,0,0,0]
    buffer_load_dwordx4 v1, s[8:11], s24 offen lds
    s_barrier
    s_waitcnt vmcnt(8)
    ds_read_b64_tr_b16 v[20:21], v4 offset:4096
    ds_read_b64_tr_b16 v[22:23], v4 offset:4608
    ds_read_b64_tr_b16 v[24:25], v5 offset:4096
    ds_read_b64_tr_b16 v[26:27], v5 offset:4608
    ds_read_b64_tr_b16 v[28:29], v6 offset:4096
    ds_read_b64_tr_b16 v[30:31], v6 offset:4608
    ds_read_b64_tr_b16 v[32:33], v7 offset:4096
    ds_read_b64_tr_b16 v[34:35], v7 offset:4608
    s_waitcnt lgkmcnt(6)
    v_mfma_f32_16x16x32_bf16 v[36:39], v[20:23], v[56:59], v[36:39]
    s_waitcnt lgkmcnt(4)
    v_mfma_f32_16x16x32_bf16 v[40:43], v[24:27], v[56:59], v[40:43]
    s_waitcnt lgkmcnt(2)
    v_mfma_f32_16x16x32_bf16 v[44:47], v[28:31], v[56:59], v[44:47]
    s_waitcnt lgkmcnt(0)
    v_mfma_f32_16x16x32_bf16 v[48:51], v[32:35], v[56:59], v[48:51]
    s_add_u32 m0, s22, 4096
    v_mad_u32_u16 v0, v16, s50, v2 op_sel:[0,0,0,0]
    buffer_load_dwordx4 v0, s[8:11], s24 offen lds
    s_add_u32 m0, s22, 5120
    v_mad_u32_u16 v1, v16, s50, v3 op_sel:[1,0,0,0]
    buffer_load_dwordx4 v1, s[8:11], s24 offen lds
    s_add_u32 m0, s22, 6144
    v_mad_u32_u16 v0, v17, s50, v2 op_sel:[0,0,0,0]
    buffer_load_dwordx4 v0, s[8:11], s24 offen lds
    s_add_u32 m0, s22, 7168
    v_mad_u32_u16 v1, v17, s50, v3 op_sel:[1,0,0,0]
    buffer_load_dwordx4 v1, s[8:11], s24 offen lds
    s_waitcnt vmcnt(8)
    ds_read_b64_tr_b16 v[20:21], v4 offset:8192
    ds_read_b64_tr_b16 v[22:23], v4 offset:8704
    ds_read_b64_tr_b16 v[24:25], v5 offset:8192
    ds_read_b64_tr_b16 v[26:27], v5 offset:8704
    ds_read_b64_tr_b16 v[28:29], v6 offset:8192
    ds_read_b64_tr_b16 v[30:31], v6 offset:8704
    ds_read_b64_tr_b16 v[32:33], v7 offset:8192
    ds_read_b64_tr_b16 v[34:35], v7 offset:8704
    s_waitcnt lgkmcnt(6)
    v_mfma_f32_16x16x32_bf16 v[36:39], v[20:23], v[60:63], v[36:39]
    s_waitcnt lgkmcnt(4)
    v_mfma_f32_16x16x32_bf16 v[40:43], v[24:27], v[60:63], v[40:43]
    s_waitcnt lgkmcnt(2)
    v_mfma_f32_16x16x32_bf16 v[44:47], v[28:31], v[60:63], v[44:47]
    s_waitcnt lgkmcnt(0)
    v_mfma_f32_16x16x32_bf16 v[48:51], v[32:35], v[60:63], v[48:51]
    s_add_u32 m0, s22, 8192
    v_mad_u32_u16 v0, v18, s50, v2 op_sel:[0,0,0,0]
    buffer_load_dwordx4 v0, s[8:11], s24 offen lds
    s_add_u32 m0, s22, 9216
    v_mad_u32_u16 v1, v18, s50, v3 op_sel:[1,0,0,0]
    buffer_load_dwordx4 v1, s[8:11], s24 offen lds
    s_add_u32 m0, s22, 10240
    v_mad_u32_u16 v0, v19, s50, v2 op_sel:[0,0,0,0]
    buffer_load_dwordx4 v0, s[8:11], s24 offen lds
    s_add_u32 m0, s22, 11264
    v_mad_u32_u16 v1, v19, s50, v3 op_sel:[1,0,0,0]
    buffer_load_dwordx4 v1, s[8:11], s24 offen lds
    s_waitcnt vmcnt(8)
    ds_read_b64_tr_b16 v[20:21], v4 offset:0
    ds_read_b64_tr_b16 v[22:23], v4 offset:512
    ds_read_b64_tr_b16 v[24:25], v5 offset:0
    ds_read_b64_tr_b16 v[26:27], v5 offset:512
    ds_read_b64_tr_b16 v[28:29], v6 offset:0
    ds_read_b64_tr_b16 v[30:31], v6 offset:512
    ds_read_b64_tr_b16 v[32:33], v7 offset:0
    ds_read_b64_tr_b16 v[34:35], v7 offset:512
    s_waitcnt lgkmcnt(6)
    v_mfma_f32_16x16x32_bf16 v[36:39], v[20:23], v[64:67], v[36:39]
    s_waitcnt lgkmcnt(4)
    v_mfma_f32_16x16x32_bf16 v[40:43], v[24:27], v[64:67], v[40:43]
    s_waitcnt lgkmcnt(2)
    v_mfma_f32_16x16x32_bf16 v[44:47], v[28:31], v[64:67], v[44:47]
    s_waitcnt lgkmcnt(0)
    v_mfma_f32_16x16x32_bf16 v[48:51], v[32:35], v[64:67], v[48:51]
    s_waitcnt vmcnt(4)
    ds_read_b64_tr_b16 v[20:21], v4 offset:4096
    ds_read_b64_tr_b16 v[22:23], v4 offset:4608
    ds_read_b64_tr_b16 v[24:25], v5 offset:4096
    ds_read_b64_tr_b16 v[26:27], v5 offset:4608
    ds_read_b64_tr_b16 v[28:29], v6 offset:4096
    ds_read_b64_tr_b16 v[30:31], v6 offset:4608
    ds_read_b64_tr_b16 v[32:33], v7 offset:4096
    ds_read_b64_tr_b16 v[34:35], v7 offset:4608
    s_waitcnt lgkmcnt(6)
    v_mfma_f32_16x16x32_bf16 v[36:39], v[20:23], v[68:71], v[36:39]
    s_waitcnt lgkmcnt(4)
    v_mfma_f32_16x16x32_bf16 v[40:43], v[24:27], v[68:71], v[40:43]
    s_waitcnt lgkmcnt(2)
    v_mfma_f32_16x16x32_bf16 v[44:47], v[28:31], v[68:71], v[44:47]
    s_waitcnt lgkmcnt(0)
    v_mfma_f32_16x16x32_bf16 v[48:51], v[32:35], v[68:71], v[48:51]
    s_waitcnt vmcnt(0)
    ds_read_b64_tr_b16 v[20:21], v4 offset:8192
    ds_read_b64_tr_b16 v[22:23], v4 offset:8704
    ds_read_b64_tr_b16 v[24:25], v5 offset:8192
    ds_read_b64_tr_b16 v[26:27], v5 offset:8704
    ds_read_b64_tr_b16 v[28:29], v6 offset:8192
    ds_read_b64_tr_b16 v[30:31], v6 offset:8704
    ds_read_b64_tr_b16 v[32:33], v7 offset:8192
    ds_read_b64_tr_b16 v[34:35], v7 offset:8704
    s_waitcnt lgkmcnt(6)
    v_mfma_f32_16x16x32_bf16 v[36:39], v[20:23], v[72:75], v[36:39]
    s_waitcnt lgkmcnt(4)
    v_mfma_f32_16x16x32_bf16 v[40:43], v[24:27], v[72:75], v[40:43]
    s_waitcnt lgkmcnt(2)
    v_mfma_f32_16x16x32_bf16 v[44:47], v[28:31], v[72:75], v[44:47]
    s_waitcnt lgkmcnt(0)
    v_mfma_f32_16x16x32_bf16 v[48:51], v[32:35], v[72:75], v[48:51]
    s_branch K2_gap
K2_n5:
    s_waitcnt vmcnt(8)
    ds_read_b64_tr_b16 v[20:21], v4 offset:0
    ds_read_b64_tr_b16 v[22:23], v4 offset:512
    ds_read_b64_tr_b16 v[24:25], v5 offset:0
    ds_read_b64_tr_b16 v[26:27], v5 offset:512
    ds_read_b64_tr_b16 v[28:29], v6 offset:0
    ds_read_b64_tr_b16 v[30:31], v6 offset:512
    ds_read_b64_tr_b16 v[32:33], v7 offset:0
    ds_read_b64_tr_b16 v[34:35], v7 offset:512
    s_waitcnt lgkmcnt(6)
    v_mfma_f32_16x16x32_bf16 v[36:39], v[20:23], v[52:55], 0
    s_waitcnt lgkmcnt(4)
    v_mfma_f32_16x16x32_bf16 v[40:43], v[24:27], v[52:55], 0
    s_waitcnt lgkmcnt(2)
    v_mfma_f32_16x16x32_bf16 v[44:47], v[28:31], v[52:55], 0
    s_waitcnt lgkmcnt(0)
    v_mfma_f32_16x16x32_bf16 v[48:51], v[32:35], v[52:55], 0
    s_add_u32 m0, s22, 0
    v_mad_u32_u16 v0, v14, s50, v2 op_sel:[0,0,0,0]
    buffer_load_dwordx4 v0, s[8:11], s24 offen lds
    s_add_u32 m0, s22, 1024
    v_mad_u32_u16 v1, v14, s50, v3 op_sel:[1,0,0,0]
    buffer_load_dwordx4 v1, s[8:11], s24 offen lds
    s_add_u32 m0, s22, 2048
    v_mad_u32_u16 v0, v15, s50, v2 op_sel:[0,0,0,0]
    buffer_load_dwordx4 v0, s[8:11], s24 offen lds
    s_add_u32 m0, s22, 3072
    v_mad_u32_u16 v1, v15, s50, v3 op_sel:[1,0,0,0]
    buffer_load_dwordx4 v1, s[8:11], s24 offen lds
    s_barrier
    s_waitcnt vmcnt(8)
    ds_read_b64_tr_b16 v[20:21], v4 offset:4096
    ds_read_b64_tr_b16 v[22:23], v4 offset:4608
    ds_read_b64_tr_b16 v[24:25], v5 offset:4096
    ds_read_b64_tr_b16 v[26:27], v5 offset:4608
    ds_read_b64_tr_b16 v[28:29], v6 offset:4096
    ds_read_b64_tr_b16 v[30:31], v6 offset:4608
    ds_read_b64_tr_b16 v[32:33], v7 offset:4096
    ds_read_b64_tr_b16 v[34:35], v7 offset:4608
    s_waitcnt lgkmcnt(6)
    v_mfma_f32_16x16x32_bf16 v[36:39], v[20:23], v[56:59], v[36:39]
    s_waitcnt lgkmcnt(4)
    v_mfma_f32_16x16x32_bf16 v[40:43], v[24:27], v[56:59], v[40:43]
    s_waitcnt lgkmcnt(2)
    v_mfma_f32_16x16x32_bf16 v[44:47], v[28:31], v[56:59], v[44:47]
    s_waitcnt lgkmcnt(0)
    v_mfma_f32_16x16x32_bf16 v[48:51], v[32:35], v[56:59], v[48:51]
    s_add_u32 m0, s22, 4096
    v_mad_u32_u16 v0, v16, s50, v2 op_sel:[0,0,0,0]
    buffer_load_dwordx4 v0, s[8:11], s24 offen lds
    s_add_u32 m0, s22, 5120
    v_mad_u32_u16 v1, v16, s50, v3 op_sel:[1,0,0,0]
    buffer_load_dwordx4 v1, s[8:11], s24 offen lds
    s_add_u32 m0, s22, 6144
    v_mad_u32_u16 v0, v17, s50, v2 op_sel:[0,0,0,0]
    buffer_load_dwordx4 v0, s[8:11], s24 offen lds
    s_add_u32 m0, s22, 7168
    v_mad_u32_u16 v1, v17, s50, v3 op_sel:[1,0,0,0]
    buffer_load_dwordx4 v1, s[8:11], s24 offen lds
    s_waitcnt vmcnt(8)
    ds_read_b64_tr_b16 v[20:21], v4 offset:8192
    ds_read_b64_tr_b16 v[22:23], v4 offset:8704
    ds_read_b64_tr_b16 v[24:25], v5 offset:8192
    ds_read_b64_tr_b16 v[26:27], v5 offset:8704
    ds_read_b64_tr_b16 v[28:29], v6 offset:8192
    ds_read_b64_tr_b16 v[30:31], v6 offset:8704
    ds_read_b64_tr_b16 v[32:33], v7 offset:8192
    ds_read_b64_tr_b16 v[34:35], v7 offset:8704
    s_waitcnt lgkmcnt(6)
    v_mfma_f32_16x16x32_bf16 v[36:39], v[20:23], v[60:63], v[36:39]
    s_waitcnt lgkmcnt(4)
    v_mfma_f32_16x16x32_bf16 v[40:43], v[24:27], v[60:63], v[40:43]
    s_waitcnt lgkmcnt(2)
    v_mfma_f32_16x16x32_bf16 v[44:47], v[28:31], v[60:63], v[44:47]
    s_waitcnt lgkmcnt(0)
    v_mfma_f32_16x16x32_bf16 v[48:51], v[32:35], v[60:63], v[48:51]
    s_waitcnt vmcnt(4)
    ds_read_b64_tr_b16 v[20:21], v4 offset:0
    ds_read_b64_tr_b16 v[22:23], v4 offset:512
    ds_read_b64_tr_b16 v[24:25], v5 offset:0
    ds_read_b64_tr_b16 v[26:27], v5 offset:512
    ds_read_b64_tr_b16 v[28:29], v6 offset:0
    ds_read_b64_tr_b16 v[30:31], v6 offset:512
    ds_read_b64_tr_b16 v[32:33], v7 offset:0
    ds_read_b64_tr_b16 v[34:35], v7 offset:512
    s_waitcnt lgkmcnt(6)
    v_mfma_f32_16x16x32_bf16 v[36:39], v[20:23], v[64:67], v[36:39]
    s_waitcnt lgkmcnt(4)
    v_mfma_f32_16x16x32_bf16 v[40:43], v[24:27], v[64:67], v[40:43]
    s_waitcnt lgkmcnt(2)
    v_mfma_f32_16x16x32_bf16 v[44:47], v[28:31], v[64:67], v[44:47]
    s_waitcnt lgkmcnt(0)
    v_mfma_f32_16x16x32_bf16 v[48:51], v[32:35], v[64:67], v[48:51]
    s_waitcnt vmcnt(0)
    ds_read_b64_tr_b16 v[20:21], v4 offset:4096
    ds_read_b64_tr_b16 v[22:23], v4 offset:4608
    ds_read_b64_tr_b16 v[24:25], v5 offset:4096
    ds_read_b64_tr_b16 v[26:27], v5 offset:4608
    ds_read_b64_tr_b16 v[28:29], v6 offset:4096
    ds_read_b64_tr_b16 v[30:31], v6 offset:4608
    ds_read_b64_tr_b16 v[32:33], v7 offset:4096
    ds_read_b64_tr_b16 v[34:35], v7 offset:4608
    s_waitcnt lgkmcnt(6)
    v_mfma_f32_16x16x32_bf16 v[36:39], v[20:23], v[68:71], v[36:39]
    s_waitcnt lgkmcnt(4)
    v_mfma_f32_16x16x32_bf16 v[40:43], v[24:27], v[68:71], v[40:43]
    s_waitcnt lgkmcnt(2)
    v_mfma_f32_16x16x32_bf16 v[44:47], v[28:31], v[68:71], v[44:47]
    s_waitcnt lgkmcnt(0)
    v_mfma_f32_16x16x32_bf16 v[48:51], v[32:35], v[68:71], v[48:51]
    s_branch K2_gap
K2_n4:
    s_waitcnt vmcnt(8)
    ds_read_b64_tr_b16 v[20:21], v4 offset:0
    ds_read_b64_tr_b16 v[22:23], v4 offset:512
    ds_read_b64_tr_b16 v[24:25], v5 offset:0
    ds_read_b64_tr_b16 v[26:27], v5 offset:512
    ds_read_b64_tr_b16 v[28:29], v6 offset:0
    ds_read_b64_tr_b16 v[30:31], v6 offset:512
    ds_read_b64_tr_b16 v[32:33], v7 offset:0
    ds_read_b64_tr_b16 v[34:35], v7 offset:512
    s_waitcnt lgkmcnt(6)
    v_mfma_f32_16x16x32_bf16 v[36:39], v[20:23], v[52:55], 0
    s_waitcnt lgkmcnt(4)
    v_mfma_f32_16x16x32_bf16 v[40:43], v[24:27], v[52:55], 0
    s_waitcnt lgkmcnt(2)
    v_mfma_f32_16x16x32_bf16 v[44:47], v[28:31], v[52:55], 0
    s_waitcnt lgkmcnt(0)
    v_mfma_f32_16x16x32_bf16 v[48:51], v[32:35], v[52:55], 0
    s_add_u32 m0, s22, 0
    v_mad_u32_u16 v0, v14, s50, v2 op_sel:[0,0,0,0]
    buffer_load_dwordx4 v0, s[8:11], s24 offen lds
    s_add_u32 m0, s22, 1024
    v_mad_u32_u16 v1, v14, s50, v3 op_sel:[1,0,0,0]
    buffer_load_dwordx4 v1, s[8:11], s24 offen lds
    s_add_u32 m0, s22, 2048
    v_mad_u32_u16 v0, v15, s50, v2 op_sel:[0,0,0,0]
    buffer_load_dwordx4 v0, s[8:11], s24 offen lds
    s_add_u32 m0, s22, 3072
    v_mad_u32_u16 v1, v15, s50, v3 op_sel:[1,0,0,0]
    buffer_load_dwordx4 v1, s[8:11], s24 offen lds
    s_barrier
    s_waitcnt vmcnt(8)
    ds_read_b64_tr_b16 v[20:21], v4 offset:4096
    ds_read_b64_tr_b16 v[22:23], v4 offset:4608
    ds_read_b64_tr_b16 v[24:25], v5 offset:4096
    ds_read_b64_tr_b16 v[26:27], v5 offset:4608
    ds_read_b64_tr_b16 v[28:29], v6 offset:4096
    ds_read_b64_tr_b16 v[30:31], v6 offset:4608
    ds_read_b64_tr_b16 v[32:33], v7 offset:4096
    ds_read_b64_tr_b16 v[34:35], v7 offset:4608
    s_waitcnt lgkmcnt(6)
    v_mfma_f32_16x16x32_bf16 v[36:39], v[20:23], v[56:59], v[36:39]
    s_waitcnt lgkmcnt(4)
    v_mfma_f32_16x16x32_bf16 v[40:43], v[24:27], v[56:59], v[40:43]
    s_waitcnt lgkmcnt(2)
    v_mfma_f32_16x16x32_bf16 v[44:47], v[28:31], v[56:59], v[44:47]
    s_waitcnt lgkmcnt(0)
    v_mfma_f32_16x16x32_bf16 v[48:51], v[32:35], v[56:59], v[48:51]
    s_waitcnt vmcnt(4)
    ds_read_b64_tr_b16 v[20:21], v4 offset:8192
    ds_read_b64_tr_b16 v[22:23], v4 offset:8704
    ds_read_b64_tr_b16 v[24:25], v5 offset:8192
    ds_read_b64_tr_b16 v[26:27], v5 offset:8704
    ds_read_b64_tr_b16 v[28:29], v6 offset:8192
    ds_read_b64_tr_b16 v[30:31], v6 offset:8704
    ds_read_b64_tr_b16 v[32:33], v7 offset:8192
    ds_read_b64_tr_b16 v[34:35], v7 offset:8704
    s_waitcnt lgkmcnt(6)
    v_mfma_f32_16x16x32_bf16 v[36:39], v[20:23], v[60:63], v[36:39]
    s_waitcnt lgkmcnt(4)
    v_mfma_f32_16x16x32_bf16 v[40:43], v[24:27], v[60:63], v[40:43]
    s_waitcnt lgkmcnt(2)
    v_mfma_f32_16x16x32_bf16 v[44:47], v[28:31], v[60:63], v[44:47]
    s_waitcnt lgkmcnt(0)
    v_mfma_f32_16x16x32_bf16 v[48:51], v[32:35], v[60:63], v[48:51]
    s_waitcnt vmcnt(0)
    ds_read_b64_tr_b16 v[20:21], v4 offset:0
    ds_read_b64_tr_b16 v[22:23], v4 offset:512
    ds_read_b64_tr_b16 v[24:25], v5 offset:0
    ds_read_b64_tr_b16 v[26:27], v5 offset:512
    ds_read_b64_tr_b16 v[28:29], v6 offset:0
    ds_read_b64_tr_b16 v[30:31], v6 offset:512
    ds_read_b64_tr_b16 v[32:33], v7 offset:0
    ds_read_b64_tr_b16 v[34:35], v7 offset:512
    s_waitcnt lgkmcnt(6)
    v_mfma_f32_16x16x32_bf16 v[36:39], v[20:23], v[64:67], v[36:39]
    s_waitcnt lgkmcnt(4)
    v_mfma_f32_16x16x32_bf16 v[40:43], v[24:27], v[64:67], v[40:43]
    s_waitcnt lgkmcnt(2)
    v_mfma_f32_16x16x32_bf16 v[44:47], v[28:31], v[64:67], v[44:47]
    s_waitcnt lgkmcnt(0)
    v_mfma_f32_16x16x32_bf16 v[48:51], v[32:35], v[64:67], v[48:51]
K2_gap:
    s_and_b32 s37, s28, 3
    s_cmp_eq_u32 s37, 1
    s_cbranch_scc1 K2_gap_2
    s_cmp_eq_u32 s37, 2
    s_cbranch_scc1 K2_gap_3
    s_cmp_eq_u32 s28, 3
    s_cbranch_scc1 K2_gap_0
    s_cmp_eq_u32 s28, 7
    s_cbranch_scc1 K2_gap_F
K2_gap_1:
    s_add_u32 s25, s24, 256
    s_cmp_ge_u32 s20, 8
    s_cbranch_scc1 K2_nw_11
    s_cmp_lg_u32 s28, 4
    s_cbranch_scc1 K2_nw_11
    s_add_u32 s53, s29, 0
    v_mbcnt_lo_u32_b32 v1, -1, 0
    v_mbcnt_hi_u32_b32 v1, -1, v1
    v_lshlrev_b32 v1, 4, v1
    buffer_load_dwordx4 v[76:79], v1, s[12:15], s53 offen offset:0 sc1
    buffer_load_dwordx4 v[80:83], v1, s[12:15], s53 offen offset:1024 sc1
    s_add_u32 s53, s53, 4096
    buffer_load_dwordx4 v[92:95], v1, s[12:15], s53 offen offset:0 sc1
    buffer_load_dwordx4 v[96:99], v1, s[12:15], s53 offen offset:1024 sc1
K2_nw_11:
    s_add_u32 m0, s22, 0
    v_mad_u32_u16 v0, v8, s50, v2 op_sel:[0,0,0,0]
    buffer_load_dwordx4 v0, s[8:11], s25 offen lds
    s_add_u32 m0, s22, 1024
    v_mad_u32_u16 v1, v8, s50, v3 op_sel:[1,0,0,0]
    buffer_load_dwordx4 v1, s[8:11], s25 offen lds
    s_add_u32 m0, s22, 2048
    v_mad_u32_u16 v0, v9, s50, v2 op_sel:[0,0,0,0]
    buffer_load_dwordx4 v0, s[8:11], s25 offen lds
    s_add_u32 m0, s22, 3072
    v_mad_u32_u16 v1, v9, s50, v3 op_sel:[1,0,0,0]
    buffer_load_dwordx4 v1, s[8:11], s25 offen lds
    s_nop 1
    v_cvt_pk_bf16_f32 v20, v36, v37
    v_cvt_pk_bf16_f32 v21, v38, v39
    v_cvt_pk_bf16_f32 v22, v40, v41
    v_cvt_pk_bf16_f32 v23, v42, v43
    v_cvt_pk_bf16_f32 v24, v44, v45
    v_cvt_pk_bf16_f32 v25, v46, v47
    v_cvt_pk_bf16_f32 v26, v48, v49
    v_cvt_pk_bf16_f32 v27, v50, v51
    s_mov_b32 exec_lo, 0x44444444
    s_mov_b32 exec_hi, 0x44444444
    v_xor_b32 v20, 0x80008000, v20
    v_xor_b32 v21, 0x80008000, v21
    v_xor_b32 v22, 0x80008000, v22
    v_xor_b32 v23, 0x80008000, v23
    v_xor_b32 v24, 0x80008000, v24
    v_xor_b32 v25, 0x80008000, v25
    v_xor_b32 v26, 0x80008000, v26
    v_xor_b32 v27, 0x80008000, v27
    s_mov_b64 exec, -1
    ds_write_b128 v164, v[20:23]
    ds_write_b128 v164, v[24:27] offset:2560
    s_waitcnt lgkmcnt(0)
    s_barrier
    s_cmp_ge_u32 s20, 8
    s_cbranch_scc1 K2_gw_1
    ds_read_b128 v[20:23], v165 offset:0
    ds_read_b128 v[24:27], v165 offset:1024
    ds_read_b128 v[28:31], v165 offset:2048
    ds_read_b128 v[32:35], v165 offset:2560
    ds_read_b128 v[36:39], v165 offset:3584
    ds_read_b128 v[40:43], v165 offset:4608
    ds_read_b128 v[44:47], v165 offset:5136
    s_waitcnt lgkmcnt(6)
    v_mfma_f32_16x16x32_bf16 v[128:131], v[100:103], v[20:23], v[128:131]
    ds_read_b128 v[48:51], v165 offset:6160
    s_waitcnt lgkmcnt(6)
    v_mfma_f32_16x16x32_bf16 v[132:135], v[100:103], v[24:27], v[132:135]
    ds_read_b128 v[20:23], v165 offset:7184
    s_add_u32 m0, s22, 4096
    v_mad_u32_u16 v0, v10, s50, v2 op_sel:[0,0,0,0]
    buffer_load_dwordx4 v0, s[8:11], s25 offen lds
    s_waitcnt lgkmcnt(6)
    v_mfma_f32_16x16x32_bf16 v[136:139], v[100:103], v[28:31], v[136:139]
    ds_read_b128 v[24:27], v165 offset:7696
    s_waitcnt lgkmcnt(6)
    v_mfma_f32_16x16x32_bf16 v[128:131], v[104:107], v[32:35], v[128:131]
    ds_read_b128 v[28:31], v165 offset:8720
    s_waitcnt lgkmcnt(6)
    v_mfma_f32_16x16x32_bf16 v[132:135], v[104:107], v[36:39], v[132:135]
    ds_read_b128 v[32:35], v165 offset:9744
    s_add_u32 m0, s22, 5120
    v_mad_u32_u16 v1, v10, s50, v3 op_sel:[1,0,0,0]
    buffer_load_dwordx4 v1, s[8:11], s25 offen lds
    s_waitcnt lgkmcnt(6)
    v_mfma_f32_16x16x32_bf16 v[136:139], v[104:107], v[40:43], v[136:139]
    ds_read_b128 v[36:39], v165 offset:10272
    s_waitcnt lgkmcnt(6)
    v_mfma_f32_16x16x32_bf16 v[116:119], v[84:87], v[44:47], v[116:119]
    ds_read_b128 v[40:43], v165 offset:11296
    s_waitcnt lgkmcnt(6)
    v_mfma_f32_16x16x32_bf16 v[120:123], v[84:87], v[48:51], v[120:123]
    ds_read_b128 v[44:47], v165 offset:12320
    s_add_u32 m0, s22, 6144
    v_mad_u32_u16 v0, v11, s50, v2 op_sel:[0,0,0,0]
    buffer_load_dwordx4 v0, s[8:11], s25 offen lds
    s_waitcnt lgkmcnt(6)
    v_mfma_f32_16x16x32_bf16 v[124:127], v[84:87], v[20:23], v[124:127]
    ds_read_b128 v[48:51], v165 offset:12832
    s_waitcnt lgkmcnt(6)
    v_mfma_f32_16x16x32_bf16 v[116:119], v[88:91], v[24:27], v[116:119]
    ds_read_b128 v[20:23], v165 offset:13856
    s_waitcnt lgkmcnt(6)
    v_mfma_f32_16x16x32_bf16 v[120:123], v[88:91], v[28:31], v[120:123]
    ds_read_b128 v[24:27], v165 offset:14880
    s_add_u32 m0, s22, 7168
    v_mad_u32_u16 v1, v11, s50, v3 op_sel:[1,0,0,0]
    buffer_load_dwordx4 v1, s[8:11], s25 offen lds
    s_waitcnt lgkmcnt(6)
    v_mfma_f32_16x16x32_bf16 v[124:127], v[88:91], v[32:35], v[124:127]
    ds_read_b128 v[28:31], v165 offset:15408
    s_waitcnt lgkmcnt(6)
    v_mfma_f32_16x16x32_bf16 v[152:155], v[108:111], v[36:39], v[152:155]
    ds_read_b128 v[32:35], v165 offset:16432
    s_waitcnt lgkmcnt(6)
    v_mfma_f32_16x16x32_bf16 v[156:159], v[108:111], v[40:43], v[156:159]
    ds_read_b128 v[36:39], v165 offset:17456
    s_add_u32 m0, s22, 8192
    v_mad_u32_u16 v0, v12, s50, v2 op_sel:[0,0,0,0]
    buffer_load_dwordx4 v0, s[8:11], s25 offen lds
    s_waitcnt lgkmcnt(6)
    v_mfma_f32_16x16x32_bf16 v[160:163], v[108:111], v[44:47], v[160:163]
    ds_read_b128 v[40:43], v165 offset:17968
    s_waitcnt lgkmcnt(6)
    v_mfma_f32_16x16x32_bf16 v[152:155], v[112:115], v[48:51], v[152:155]
    ds_read_b128 v[44:47], v165 offset:18992
    s_waitcnt lgkmcnt(6)
    v_mfma_f32_16x16x32_bf16 v[156:159], v[112:115], v[20:23], v[156:159]
    ds_read_b128 v[48:51], v165 offset:20016
    s_add_u32 m0, s22, 9216
    v_mad_u32_u16 v1, v12, s50, v3 op_sel:[1,0,0,0]
    buffer_load_dwordx4 v1, s[8:11], s25 offen lds
    s_waitcnt lgkmcnt(6)
    v_mfma_f32_16x16x32_bf16 v[160:163], v[112:115], v[24:27], v[160:163]
    s_waitcnt lgkmcnt(5)
    v_mfma_f32_16x16x32_bf16 v[140:143], v[108:111], v[28:31], v[140:143]
    s_waitcnt lgkmcnt(4)
    v_mfma_f32_16x16x32_bf16 v[144:147], v[108:111], v[32:35], v[144:147]
    s_add_u32 m0, s22, 10240
    v_mad_u32_u16 v0, v13, s50, v2 op_sel:[0,0,0,0]
    buffer_load_dwordx4 v0, s[8:11], s25 offen lds
    s_waitcnt lgkmcnt(3)
    v_mfma_f32_16x16x32_bf16 v[148:151], v[108:111], v[36:39], v[148:151]
    s_waitcnt lgkmcnt(2)
    v_mfma_f32_16x16x32_bf16 v[140:143], v[112:115], v[40:43], v[140:143]
    s_waitcnt lgkmcnt(1)
    v_mfma_f32_16x16x32_bf16 v[144:147], v[112:115], v[44:47], v[144:147]
    s_add_u32 m0, s22, 11264
    v_mad_u32_u16 v1, v13, s50, v3 op_sel:[1,0,0,0]
    buffer_load_dwordx4 v1, s[8:11], s25 offen lds
    s_waitcnt lgkmcnt(0)
    v_mfma_f32_16x16x32_bf16 v[148:151], v[112:115], v[48:51], v[148:151]
    s_branch K2_gn_1
K2_gw_1:
    s_add_u32 m0, s22, 4096
    v_mad_u32_u16 v0, v10, s50, v2 op_sel:[0,0,0,0]
    buffer_load_dwordx4 v0, s[8:11], s25 offen lds
    s_add_u32 m0, s22, 5120
    v_mad_u32_u16 v1, v10, s50, v3 op_sel:[1,0,0,0]
    buffer_load_dwordx4 v1, s[8:11], s25 offen lds
    s_add_u32 m0, s22, 6144
    v_mad_u32_u16 v0, v11, s50, v2 op_sel:[0,0,0,0]
    buffer_load_dwordx4 v0, s[8:11], s25 offen lds
    s_add_u32 m0, s22, 7168
    v_mad_u32_u16 v1, v11, s50, v3 op_sel:[1,0,0,0]
    buffer_load_dwordx4 v1, s[8:11], s25 offen lds
    s_add_u32 m0, s22, 8192
    v_mad_u32_u16 v0, v12, s50, v2 op_sel:[0,0,0,0]
    buffer_load_dwordx4 v0, s[8:11], s25 offen lds
    s_add_u32 m0, s22, 9216
    v_mad_u32_u16 v1, v12, s50, v3 op_sel:[1,0,0,0]
    buffer_load_dwordx4 v1, s[8:11], s25 offen lds
    s_add_u32 m0, s22, 10240
    v_mad_u32_u16 v0, v13, s50, v2 op_sel:[0,0,0,0]
    buffer_load_dwordx4 v0, s[8:11], s25 offen lds
    s_add_u32 m0, s22, 11264
    v_mad_u32_u16 v1, v13, s50, v3 op_sel:[1,0,0,0]
    buffer_load_dwordx4 v1, s[8:11], s25 offen lds
K2_gn_1:
    s_mov_b32 s24, s25
    s_add_u32 s28, s28, 1
    s_branch K2_slice
K2_gap_0:
    s_mov_b32 s25, 256
    s_cmp_ge_u32 s20, 8
    s_cbranch_scc1 K2_nw_12
    s_mov_b32 s53, s29
    v_mbcnt_lo_u32_b32 v1, -1, 0
    v_mbcnt_hi_u32_b32 v1, -1, v1
    v_lshlrev_b32 v1, 4, v1
    buffer_load_dwordx4 v[84:87], v1, s[12:15], s53 offen offset:2048 sc1
    buffer_load_dwordx4 v[88:91], v1, s[12:15], s53 offen offset:3072 sc1
    s_add_u32 s53, s53, 4096
    buffer_load_dwordx4 v[100:103], v1, s[12:15], s53 offen offset:2048 sc1
    buffer_load_dwordx4 v[104:107], v1, s[12:15], s53 offen offset:3072 sc1
    s_add_u32 s53, s53, 4096
    buffer_load_dwordx4 v[108:111], v1, s[12:15], s53 offen offset:0 sc1
    buffer_load_dwordx4 v[112:115], v1, s[12:15], s53 offen offset:1024 sc1
K2_nw_12:
    s_add_u32 m0, s22, 0
    v_mad_u32_u16 v0, v8, s50, v2 op_sel:[0,0,0,0]
    buffer_load_dwordx4 v0, s[8:11], s25 offen lds
    s_add_u32 m0, s22, 1024
    v_mad_u32_u16 v1, v8, s50, v3 op_sel:[1,0,0,0]
    buffer_load_dwordx4 v1, s[8:11], s25 offen lds
    s_add_u32 m0, s22, 2048
    v_mad_u32_u16 v0, v9, s50, v2 op_sel:[0,0,0,0]
    buffer_load_dwordx4 v0, s[8:11], s25 offen lds
    s_add_u32 m0, s22, 3072
    v_mad_u32_u16 v1, v9, s50, v3 op_sel:[1,0,0,0]
    buffer_load_dwordx4 v1, s[8:11], s25 offen lds
    s_nop 1
    v_cvt_pk_bf16_f32 v20, v36, v37
    v_cvt_pk_bf16_f32 v21, v38, v39
    v_cvt_pk_bf16_f32 v22, v40, v41
    v_cvt_pk_bf16_f32 v23, v42, v43
    v_cvt_pk_bf16_f32 v24, v44, v45
    v_cvt_pk_bf16_f32 v25, v46, v47
    v_cvt_pk_bf16_f32 v26, v48, v49
    v_cvt_pk_bf16_f32 v27, v50, v51
    ds_write_b128 v164, v[20:23]
    ds_write_b128 v164, v[24:27] offset:2560
    s_waitcnt lgkmcnt(0)
    s_barrier
    s_cmp_ge_u32 s20, 8
    s_cbranch_scc1 K2_gw_0
    ds_read_b128 v[20:23], v165 offset:0
    ds_read_b128 v[24:27], v165 offset:1024
    ds_read_b128 v[28:31], v165 offset:2048
    ds_read_b128 v[32:35], v165 offset:2560
    ds_read_b128 v[36:39], v165 offset:3584
    ds_read_b128 v[40:43], v165 offset:4608
    ds_read_b128 v[44:47], v165 offset:5136
    s_waitcnt lgkmcnt(6)
    v_mfma_f32_16x16x32_bf16 v[116:119], v[76:79], v[20:23], v[116:119]
    ds_read_b128 v[48:51], v165 offset:6160
    s_waitcnt lgkmcnt(6)
    v_mfma_f32_16x16x32_bf16 v[120:123], v[76:79], v[24:27], v[120:123]
    ds_read_b128 v[20:23], v165 offset:7184
    s_add_u32 m0, s22, 4096
    v_mad_u32_u16 v0, v10, s50, v2 op_sel:[0,0,0,0]
    buffer_load_dwordx4 v0, s[8:11], s25 offen lds
    s_waitcnt lgkmcnt(6)
    v_mfma_f32_16x16x32_bf16 v[124:127], v[76:79], v[28:31], v[124:127]
    ds_read_b128 v[24:27], v165 offset:7696
    s_waitcnt lgkmcnt(6)
    v_mfma_f32_16x16x32_bf16 v[116:119], v[80:83], v[32:35], v[116:119]
    ds_read_b128 v[28:31], v165 offset:8720
    s_waitcnt lgkmcnt(6)
    v_mfma_f32_16x16x32_bf16 v[120:123], v[80:83], v[36:39], v[120:123]
    ds_read_b128 v[32:35], v165 offset:9744
    s_add_u32 m0, s22, 5120
    v_mad_u32_u16 v1, v10, s50, v3 op_sel:[1,0,0,0]
    buffer_load_dwordx4 v1, s[8:11], s25 offen lds
    s_waitcnt lgkmcnt(6)
    v_mfma_f32_16x16x32_bf16 v[124:127], v[80:83], v[40:43], v[124:127]
    ds_read_b128 v[36:39], v165 offset:10272
    s_waitcnt lgkmcnt(6)
    v_mfma_f32_16x16x32_bf16 v[128:131], v[92:95], v[44:47], v[128:131]
    ds_read_b128 v[40:43], v165 offset:11296
    s_waitcnt lgkmcnt(6)
    v_mfma_f32_16x16x32_bf16 v[132:135], v[92:95], v[48:51], v[132:135]
    ds_read_b128 v[44:47], v165 offset:12320
    s_add_u32 m0, s22, 6144
    v_mad_u32_u16 v0, v11, s50, v2 op_sel:[0,0,0,0]
    buffer_load_dwordx4 v0, s[8:11], s25 offen lds
    s_waitcnt lgkmcnt(6)
    v_mfma_f32_16x16x32_bf16 v[136:139], v[92:95], v[20:23], v[136:139]
    ds_read_b128 v[48:51], v165 offset:12832
    s_waitcnt lgkmcnt(6)
    v_mfma_f32_16x16x32_bf16 v[128:131], v[96:99], v[24:27], v[128:131]
    ds_read_b128 v[20:23], v165 offset:13856
    s_waitcnt lgkmcnt(6)
    v_mfma_f32_16x16x32_bf16 v[132:135], v[96:99], v[28:31], v[132:135]
    ds_read_b128 v[24:27], v165 offset:14880
    s_add_u32 m0, s22, 7168
    v_mad_u32_u16 v1, v11, s50, v3 op_sel:[1,0,0,0]
    buffer_load_dwordx4 v1, s[8:11], s25 offen lds
    s_waitcnt lgkmcnt(6)
    v_mfma_f32_16x16x32_bf16 v[136:139], v[96:99], v[32:35], v[136:139]
    ds_read_b128 v[28:31], v165 offset:15408
    s_waitcnt lgkmcnt(6)
    v_mfma_f32_16x16x32_bf16 v[140:143], v[92:95], v[36:39], v[140:143]
    ds_read_b128 v[32:35], v165 offset:16432
    s_waitcnt lgkmcnt(6)
    v_mfma_f32_16x16x32_bf16 v[144:147], v[92:95], v[40:43], v[144:147]
    ds_read_b128 v[36:39], v165 offset:17456
    s_add_u32 m0, s22, 8192
    v_mad_u32_u16 v0, v12, s50, v2 op_sel:[0,0,0,0]
    buffer_load_dwordx4 v0, s[8:11], s25 offen lds
    s_waitcnt lgkmcnt(6)
    v_mfma_f32_16x16x32_bf16 v[148:151], v[92:95], v[44:47], v[148:151]
    ds_read_b128 v[40:43], v165 offset:17968
    s_waitcnt lgkmcnt(6)
    v_mfma_f32_16x16x32_bf16 v[140:143], v[96:99], v[48:51], v[140:143]
    ds_read_b128 v[44:47], v165 offset:18992
    s_waitcnt lgkmcnt(6)
    v_mfma_f32_16x16x32_bf16 v[144:147], v[96:99], v[20:23], v[144:147]
    ds_read_b128 v[48:51], v165 offset:20016
    s_add_u32 m0, s22, 9216
    v_mad_u32_u16 v1, v12, s50, v3 op_sel:[1,0,0,0]
    buffer_load_dwordx4 v1, s[8:11], s25 offen lds
    s_waitcnt lgkmcnt(6)
    v_mfma_f32_16x16x32_bf16 v[148:151], v[96:99], v[24:27], v[148:151]
    s_waitcnt lgkmcnt(5)
    v_mfma_f32_16x16x32_bf16 v[152:155], v[92:95], v[28:31], v[152:155]
    s_waitcnt lgkmcnt(4)
    v_mfma_f32_16x16x32_bf16 v[156:159], v[92:95], v[32:35], v[156:159]
    s_add_u32 m0, s22, 10240
    v_mad_u32_u16 v0, v13, s50, v2 op_sel:[0,0,0,0]
    buffer_load_dwordx4 v0, s[8:11], s25 offen lds
    s_waitcnt lgkmcnt(3)
    v_mfma_f32_16x16x32_bf16 v[160:163], v[92:95], v[36:39], v[160:163]
    s_waitcnt lgkmcnt(2)
    v_mfma_f32_16x16x32_bf16 v[152:155], v[96:99], v[40:43], v[152:155]
    s_waitcnt lgkmcnt(1)
    v_mfma_f32_16x16x32_bf16 v[156:159], v[96:99], v[44:47], v[156:159]
    s_add_u32 m0, s22, 11264
    v_mad_u32_u16 v1, v13, s50, v3 op_sel:[1,0,0,0]
    buffer_load_dwordx4 v1, s[8:11], s25 offen lds
    s_waitcnt lgkmcnt(0)
    v_mfma_f32_16x16x32_bf16 v[160:163], v[96:99], v[48:51], v[160:163]
    s_branch K2_gn_0
K2_gw_0:
    s_add_u32 m0, s22, 4096
    v_mad_u32_u16 v0, v10, s50, v2 op_sel:[0,0,0,0]
    buffer_load_dwordx4 v0, s[8:11], s25 offen lds
    s_add_u32 m0, s22, 5120
    v_mad_u32_u16 v1, v10, s50, v3 op_sel:[1,0,0,0]
    buffer_load_dwordx4 v1, s[8:11], s25 offen lds
    s_add_u32 m0, s22, 6144
    v_mad_u32_u16 v0, v11, s50, v2 op_sel:[0,0,0,0]
    buffer_load_dwordx4 v0, s[8:11], s25 offen lds
    s_add_u32 m0, s22, 7168
    v_mad_u32_u16 v1, v11, s50, v3 op_sel:[1,0,0,0]
    buffer_load_dwordx4 v1, s[8:11], s25 offen lds
    s_add_u32 m0, s22, 8192
    v_mad_u32_u16 v0, v12, s50, v2 op_sel:[0,0,0,0]
    buffer_load_dwordx4 v0, s[8:11], s25 offen lds
    s_add_u32 m0, s22, 9216
    v_mad_u32_u16 v1, v12, s50, v3 op_sel:[1,0,0,0]
    buffer_load_dwordx4 v1, s[8:11], s25 offen lds
    s_add_u32 m0, s22, 10240
    v_mad_u32_u16 v0, v13, s50, v2 op_sel:[0,0,0,0]
    buffer_load_dwordx4 v0, s[8:11], s25 offen lds
    s_add_u32 m0, s22, 11264
    v_mad_u32_u16 v1, v13, s50, v3 op_sel:[1,0,0,0]
    buffer_load_dwordx4 v1, s[8:11], s25 offen lds
K2_gn_0:
    s_mov_b32 s24, s25
    s_add_u32 s28, s28, 1
    s_branch K2_slice
K2_gap_2:
    s_add_u32 s25, s24, 256
    s_add_u32 m0, s22, 0
    v_mad_u32_u16 v0, v8, s50, v2 op_sel:[0,0,0,0]
    buffer_load_dwordx4 v0, s[8:11], s25 offen lds
    s_add_u32 m0, s22, 1024
    v_mad_u32_u16 v1, v8, s50, v3 op_sel:[1,0,0,0]
    buffer_load_dwordx4 v1, s[8:11], s25 offen lds
    s_add_u32 m0, s22, 2048
    v_mad_u32_u16 v0, v9, s50, v2 op_sel:[0,0,0,0]
    buffer_load_dwordx4 v0, s[8:11], s25 offen lds
    s_add_u32 m0, s22, 3072
    v_mad_u32_u16 v1, v9, s50, v3 op_sel:[1,0,0,0]
    buffer_load_dwordx4 v1, s[8:11], s25 offen lds
    s_nop 1
    v_cvt_pk_bf16_f32 v20, v36, v37
    v_cvt_pk_bf16_f32 v21, v38, v39
    v_cvt_pk_bf16_f32 v22, v40, v41
    v_cvt_pk_bf16_f32 v23, v42, v43
    v_cvt_pk_bf16_f32 v24, v44, v45
    v_cvt_pk_bf16_f32 v25, v46, v47
    v_cvt_pk_bf16_f32 v26, v48, v49
    v_cvt_pk_bf16_f32 v27, v50, v51
    s_mov_b32 exec_lo, 0x88888888
    s_mov_b32 exec_hi, 0x88888888
    v_xor_b32 v20, 0x80008000, v20
    v_xor_b32 v21, 0x80008000, v21
    v_xor_b32 v22, 0x80008000, v22
    v_xor_b32 v23, 0x80008000, v23
    v_xor_b32 v24, 0x80008000, v24
    v_xor_b32 v25, 0x80008000, v25
    v_xor_b32 v26, 0x80008000, v26
    v_xor_b32 v27, 0x80008000, v27
    s_mov_b64 exec, -1
    ds_write_b128 v164, v[20:23]
    ds_write_b128 v164, v[24:27] offset:2560
    s_waitcnt lgkmcnt(0)
    s_barrier
    s_cmp_ge_u32 s20, 8
    s_cbranch_scc1 K2_gw_2
    ds_read_b128 v[20:23], v165 offset:0
    ds_read_b128 v[24:27], v165 offset:1024
    ds_read_b128 v[28:31], v165 offset:2048
    ds_read_b128 v[32:35], v165 offset:2560
    ds_read_b128 v[36:39], v165 offset:3584
    ds_read_b128 v[40:43], v165 offset:4608
    ds_read_b128 v[44:47], v165 offset:10272
    s_waitcnt lgkmcnt(6)
    v_mfma_f32_16x16x32_bf16 v[140:143], v[100:103], v[20:23], v[140:143]
    ds_read_b128 v[48:51], v165 offset:11296
    s_waitcnt lgkmcnt(6)
    v_mfma_f32_16x16x32_bf16 v[144:147], v[100:103], v[24:27], v[144:147]
    ds_read_b128 v[20:23], v165 offset:12320
    s_add_u32 m0, s22, 4096
    v_mad_u32_u16 v0, v10, s50, v2 op_sel:[0,0,0,0]
    buffer_load_dwordx4 v0, s[8:11], s25 offen lds
    s_waitcnt lgkmcnt(6)
    v_mfma_f32_16x16x32_bf16 v[148:151], v[100:103], v[28:31], v[148:151]
    ds_read_b128 v[24:27], v165 offset:12832
    s_waitcnt lgkmcnt(6)
    v_mfma_f32_16x16x32_bf16 v[140:143], v[104:107], v[32:35], v[140:143]
    ds_read_b128 v[28:31], v165 offset:13856
    s_waitcnt lgkmcnt(6)
    v_mfma_f32_16x16x32_bf16 v[144:147], v[104:107], v[36:39], v[144:147]
    ds_read_b128 v[32:35], v165 offset:14880
    s_add_u32 m0, s22, 5120
    v_mad_u32_u16 v1, v10, s50, v3 op_sel:[1,0,0,0]
    buffer_load_dwordx4 v1, s[8:11], s25 offen lds
    s_waitcnt lgkmcnt(6)
    v_mfma_f32_16x16x32_bf16 v[148:151], v[104:107], v[40:43], v[148:151]
    ds_read_b128 v[36:39], v165 offset:5136
    s_waitcnt lgkmcnt(6)
    v_mfma_f32_16x16x32_bf16 v[116:119], v[84:87], v[44:47], v[116:119]
    ds_read_b128 v[40:43], v165 offset:6160
    s_waitcnt lgkmcnt(6)
    v_mfma_f32_16x16x32_bf16 v[120:123], v[84:87], v[48:51], v[120:123]
    ds_read_b128 v[44:47], v165 offset:7184
    s_add_u32 m0, s22, 6144
    v_mad_u32_u16 v0, v11, s50, v2 op_sel:[0,0,0,0]
    buffer_load_dwordx4 v0, s[8:11], s25 offen lds
    s_waitcnt lgkmcnt(6)
    v_mfma_f32_16x16x32_bf16 v[124:127], v[84:87], v[20:23], v[124:127]
    ds_read_b128 v[48:51], v165 offset:7696
    s_waitcnt lgkmcnt(6)
    v_mfma_f32_16x16x32_bf16 v[116:119], v[88:91], v[24:27], v[116:119]
    ds_read_b128 v[20:23], v165 offset:8720
    s_waitcnt lgkmcnt(6)
    v_mfma_f32_16x16x32_bf16 v[120:123], v[88:91], v[28:31], v[120:123]
    ds_read_b128 v[24:27], v165 offset:9744
    s_add_u32 m0, s22, 7168
    v_mad_u32_u16 v1, v11, s50, v3 op_sel:[1,0,0,0]
    buffer_load_dwordx4 v1, s[8:11], s25 offen lds
    s_waitcnt lgkmcnt(6)
    v_mfma_f32_16x16x32_bf16 v[124:127], v[88:91], v[32:35], v[124:127]
    ds_read_b128 v[28:31], v165 offset:15408
    s_waitcnt lgkmcnt(6)
    v_mfma_f32_16x16x32_bf16 v[152:155], v[108:111], v[36:39], v[152:155]
    ds_read_b128 v[32:35], v165 offset:16432
    s_waitcnt lgkmcnt(6)
    v_mfma_f32_16x16x32_bf16 v[156:159], v[108:111], v[40:43], v[156:159]
    ds_read_b128 v[36:39], v165 offset:17456
    s_add_u32 m0, s22, 8192
    v_mad_u32_u16 v0, v12, s50, v2 op_sel:[0,0,0,0]
    buffer_load_dwordx4 v0, s[8:11], s25 offen lds
    s_waitcnt lgkmcnt(6)
    v_mfma_f32_16x16x32_bf16 v[160:163], v[108:111], v[44:47], v[160:163]
    ds_read_b128 v[40:43], v165 offset:17968
    s_waitcnt lgkmcnt(6)
    v_mfma_f32_16x16x32_bf16 v[152:155], v[112:115], v[48:51], v[152:155]
    ds_read_b128 v[44:47], v165 offset:18992
    s_waitcnt lgkmcnt(6)
    v_mfma_f32_16x16x32_bf16 v[156:159], v[112:115], v[20:23], v[156:159]
    ds_read_b128 v[48:51], v165 offset:20016
    s_add_u32 m0, s22, 9216
    v_mad_u32_u16 v1, v12, s50, v3 op_sel:[1,0,0,0]
    buffer_load_dwordx4 v1, s[8:11], s25 offen lds
    s_waitcnt lgkmcnt(6)
    v_mfma_f32_16x16x32_bf16 v[160:163], v[112:115], v[24:27], v[160:163]
    s_waitcnt lgkmcnt(5)
    v_mfma_f32_16x16x32_bf16 v[128:131], v[108:111], v[28:31], v[128:131]
    s_waitcnt lgkmcnt(4)
    v_mfma_f32_16x16x32_bf16 v[132:135], v[108:111], v[32:35], v[132:135]
    s_add_u32 m0, s22, 10240
    v_mad_u32_u16 v0, v13, s50, v2 op_sel:[0,0,0,0]
    buffer_load_dwordx4 v0, s[8:11], s25 offen lds
    s_waitcnt lgkmcnt(3)
    v_mfma_f32_16x16x32_bf16 v[136:139], v[108:111], v[36:39], v[136:139]
    s_waitcnt lgkmcnt(2)
    v_mfma_f32_16x16x32_bf16 v[128:131], v[112:115], v[40:43], v[128:131]
    s_waitcnt lgkmcnt(1)
    v_mfma_f32_16x16x32_bf16 v[132:135], v[112:115], v[44:47], v[132:135]
    s_add_u32 m0, s22, 11264
    v_mad_u32_u16 v1, v13, s50, v3 op_sel:[1,0,0,0]
    buffer_load_dwordx4 v1, s[8:11], s25 offen lds
    s_waitcnt lgkmcnt(0)
    v_mfma_f32_16x16x32_bf16 v[136:139], v[112:115], v[48:51], v[136:139]
    s_branch K2_gn_2
K2_gw_2:
    s_add_u32 m0, s22, 4096
    v_mad_u32_u16 v0, v10, s50, v2 op_sel:[0,0,0,0]
    buffer_load_dwordx4 v0, s[8:11], s25 offen lds
    s_add_u32 m0, s22, 5120
    v_mad_u32_u16 v1, v10, s50, v3 op_sel:[1,0,0,0]
    buffer_load_dwordx4 v1, s[8:11], s25 offen lds
    s_add_u32 m0, s22, 6144
    v_mad_u32_u16 v0, v11, s50, v2 op_sel:[0,0,0,0]
    buffer_load_dwordx4 v0, s[8:11], s25 offen lds
    s_add_u32 m0, s22, 7168
    v_mad_u32_u16 v1, v11, s50, v3 op_sel:[1,0,0,0]
    buffer_load_dwordx4 v1, s[8:11], s25 offen lds
    s_add_u32 m0, s22, 8192
    v_mad_u32_u16 v0, v12, s50, v2 op_sel:[0,0,0,0]
    buffer_load_dwordx4 v0, s[8:11], s25 offen lds
    s_add_u32 m0, s22, 9216
    v_mad_u32_u16 v1, v12, s50, v3 op_sel:[1,0,0,0]
    buffer_load_dwordx4 v1, s[8:11], s25 offen lds
    s_add_u32 m0, s22, 10240
    v_mad_u32_u16 v0, v13, s50, v2 op_sel:[0,0,0,0]
    buffer_load_dwordx4 v0, s[8:11], s25 offen lds
    s_add_u32 m0, s22, 11264
    v_mad_u32_u16 v1, v13, s50, v3 op_sel:[1,0,0,0]
    buffer_load_dwordx4 v1, s[8:11], s25 offen lds
K2_gn_2:
    s_mov_b32 s24, s25
    s_add_u32 s28, s28, 1
    s_branch K2_slice
K2_gap_3:
    s_sub_u32 s25, s24, 768
    s_add_u32 m0, s22, 0
    v_mad_u32_u16 v0, v8, s50, v2 op_sel:[0,0,0,0]
    buffer_load_dwordx4 v0, s[8:11], s25 offen lds
    s_add_u32 m0, s22, 1024
    v_mad_u32_u16 v1, v8, s50, v3 op_sel:[1,0,0,0]
    buffer_load_dwordx4 v1, s[8:11], s25 offen lds
    s_add_u32 m0, s22, 2048
    v_mad_u32_u16 v0, v9, s50, v2 op_sel:[0,0,0,0]
    buffer_load_dwordx4 v0, s[8:11], s25 offen lds
    s_add_u32 m0, s22, 3072
    v_mad_u32_u16 v1, v9, s50, v3 op_sel:[1,0,0,0]
    buffer_load_dwordx4 v1, s[8:11], s25 offen lds
    s_nop 1
    v_cvt_pk_bf16_f32 v20, v36, v37
    v_cvt_pk_bf16_f32 v21, v38, v39
    v_cvt_pk_bf16_f32 v22, v40, v41
    v_cvt_pk_bf16_f32 v23, v42, v43
    v_cvt_pk_bf16_f32 v24, v44, v45
    v_cvt_pk_bf16_f32 v25, v46, v47
    v_cvt_pk_bf16_f32 v26, v48, v49
    v_cvt_pk_bf16_f32 v27, v50, v51
    s_mov_b32 exec_lo, 0x22222222
    s_mov_b32 exec_hi, 0x22222222
    v_xor_b32 v20, 0x80008000, v20
    v_xor_b32 v21, 0x80008000, v21
    v_xor_b32 v22, 0x80008000, v22
    v_xor_b32 v23, 0x80008000, v23
    v_xor_b32 v24, 0x80008000, v24
    v_xor_b32 v25, 0x80008000, v25
    v_xor_b32 v26, 0x80008000, v26
    v_xor_b32 v27, 0x80008000, v27
    s_mov_b64 exec, -1
    ds_write_b128 v164, v[20:23]
    ds_write_b128 v164, v[24:27] offset:2560
    s_waitcnt lgkmcnt(0)
    s_barrier
    s_cmp_ge_u32 s20, 8
    s_cbranch_scc1 K2_gw_3
    ds_read_b128 v[20:23], v165 offset:0
    ds_read_b128 v[24:27], v165 offset:1024
    ds_read_b128 v[28:31], v165 offset:2048
    ds_read_b128 v[32:35], v165 offset:2560
    ds_read_b128 v[36:39], v165 offset:3584
    ds_read_b128 v[40:43], v165 offset:4608
    ds_read_b128 v[44:47], v165 offset:15408
    s_waitcnt lgkmcnt(6)
    v_mfma_f32_16x16x32_bf16 v[152:155], v[100:103], v[20:23], v[152:155]
    ds_read_b128 v[48:51], v165 offset:16432
    s_waitcnt lgkmcnt(6)
    v_mfma_f32_16x16x32_bf16 v[156:159], v[100:103], v[24:27], v[156:159]
    ds_read_b128 v[20:23], v165 offset:17456
    s_add_u32 m0, s22, 4096
    v_mad_u32_u16 v0, v10, s50, v2 op_sel:[0,0,0,0]
    buffer_load_dwordx4 v0, s[8:11], s25 offen lds
    s_waitcnt lgkmcnt(6)
    v_mfma_f32_16x16x32_bf16 v[160:163], v[100:103], v[28:31], v[160:163]
    ds_read_b128 v[24:27], v165 offset:17968
    s_waitcnt lgkmcnt(6)
    v_mfma_f32_16x16x32_bf16 v[152:155], v[104:107], v[32:35], v[152:155]
    ds_read_b128 v[28:31], v165 offset:18992
    s_waitcnt lgkmcnt(6)
    v_mfma_f32_16x16x32_bf16 v[156:159], v[104:107], v[36:39], v[156:159]
    ds_read_b128 v[32:35], v165 offset:20016
    s_add_u32 m0, s22, 5120
    v_mad_u32_u16 v1, v10, s50, v3 op_sel:[1,0,0,0]
    buffer_load_dwordx4 v1, s[8:11], s25 offen lds
    s_waitcnt lgkmcnt(6)
    v_mfma_f32_16x16x32_bf16 v[160:163], v[104:107], v[40:43], v[160:163]
    ds_read_b128 v[36:39], v165 offset:5136
    s_waitcnt lgkmcnt(6)
    v_mfma_f32_16x16x32_bf16 v[116:119], v[84:87], v[44:47], v[116:119]
    ds_read_b128 v[40:43], v165 offset:6160
    s_waitcnt lgkmcnt(6)
    v_mfma_f32_16x16x32_bf16 v[120:123], v[84:87], v[48:51], v[120:123]
    ds_read_b128 v[44:47], v165 offset:7184
    s_add_u32 m0, s22, 6144
    v_mad_u32_u16 v0, v11, s50, v2 op_sel:[0,0,0,0]
    buffer_load_dwordx4 v0, s[8:11], s25 offen lds
    s_waitcnt lgkmcnt(6)
    v_mfma_f32_16x16x32_bf16 v[124:127], v[84:87], v[20:23], v[124:127]
    ds_read_b128 v[48:51], v165 offset:7696
    s_waitcnt lgkmcnt(6)
    v_mfma_f32_16x16x32_bf16 v[116:119], v[88:91], v[24:27], v[116:119]
    ds_read_b128 v[20:23], v165 offset:8720
    s_waitcnt lgkmcnt(6)
    v_mfma_f32_16x16x32_bf16 v[120:123], v[88:91], v[28:31], v[120:123]
    ds_read_b128 v[24:27], v165 offset:9744
    s_add_u32 m0, s22, 7168
    v_mad_u32_u16 v1, v11, s50, v3 op_sel:[1,0,0,0]
    buffer_load_dwordx4 v1, s[8:11], s25 offen lds
    s_waitcnt lgkmcnt(6)
    v_mfma_f32_16x16x32_bf16 v[124:127], v[88:91], v[32:35], v[124:127]
    ds_read_b128 v[28:31], v165 offset:10272
    s_waitcnt lgkmcnt(6)
    v_mfma_f32_16x16x32_bf16 v[140:143], v[108:111], v[36:39], v[140:143]
    ds_read_b128 v[32:35], v165 offset:11296
    s_waitcnt lgkmcnt(6)
    v_mfma_f32_16x16x32_bf16 v[144:147], v[108:111], v[40:43], v[144:147]
    ds_read_b128 v[36:39], v165 offset:12320
    s_add_u32 m0, s22, 8192
    v_mad_u32_u16 v0, v12, s50, v2 op_sel:[0,0,0,0]
    buffer_load_dwordx4 v0, s[8:11], s25 offen lds
    s_waitcnt lgkmcnt(6)
    v_mfma_f32_16x16x32_bf16 v[148:151], v[108:111], v[44:47], v[148:151]
    ds_read_b128 v[40:43], v165 offset:12832
    s_waitcnt lgkmcnt(6)
    v_mfma_f32_16x16x32_bf16 v[140:143], v[112:115], v[48:51], v[140:143]
    ds_read_b128 v[44:47], v165 offset:13856
    s_waitcnt lgkmcnt(6)
    v_mfma_f32_16x16x32_bf16 v[144:147], v[112:115], v[20:23], v[144:147]
    ds_read_b128 v[48:51], v165 offset:14880
    s_add_u32 m0, s22, 9216
    v_mad_u32_u16 v1, v12, s50, v3 op_sel:[1,0,0,0]
    buffer_load_dwordx4 v1, s[8:11], s25 offen lds
    s_waitcnt lgkmcnt(6)
    v_mfma_f32_16x16x32_bf16 v[148:151], v[112:115], v[24:27], v[148:151]
    s_waitcnt lgkmcnt(5)
    v_mfma_f32_16x16x32_bf16 v[128:131], v[108:111], v[28:31], v[128:131]
    s_waitcnt lgkmcnt(4)
    v_mfma_f32_16x16x32_bf16 v[132:135], v[108:111], v[32:35], v[132:135]
    s_add_u32 m0, s22, 10240
    v_mad_u32_u16 v0, v13, s50, v2 op_sel:[0,0,0,0]
    buffer_load_dwordx4 v0, s[8:11], s25 offen lds
    s_waitcnt lgkmcnt(3)
    v_mfma_f32_16x16x32_bf16 v[136:139], v[108:111], v[36:39], v[136:139]
    s_waitcnt lgkmcnt(2)
    v_mfma_f32_16x16x32_bf16 v[128:131], v[112:115], v[40:43], v[128:131]
    s_waitcnt lgkmcnt(1)
    v_mfma_f32_16x16x32_bf16 v[132:135], v[112:115], v[44:47], v[132:135]
    s_add_u32 m0, s22, 11264
    v_mad_u32_u16 v1, v13, s50, v3 op_sel:[1,0,0,0]
    buffer_load_dwordx4 v1, s[8:11], s25 offen lds
    s_waitcnt lgkmcnt(0)
    v_mfma_f32_16x16x32_bf16 v[136:139], v[112:115], v[48:51], v[136:139]
    s_branch K2_gn_3
K2_gw_3:
    s_add_u32 m0, s22, 4096
    v_mad_u32_u16 v0, v10, s50, v2 op_sel:[0,0,0,0]
    buffer_load_dwordx4 v0, s[8:11], s25 offen lds
    s_add_u32 m0, s22, 5120
    v_mad_u32_u16 v1, v10, s50, v3 op_sel:[1,0,0,0]
    buffer_load_dwordx4 v1, s[8:11], s25 offen lds
    s_add_u32 m0, s22, 6144
    v_mad_u32_u16 v0, v11, s50, v2 op_sel:[0,0,0,0]
    buffer_load_dwordx4 v0, s[8:11], s25 offen lds
    s_add_u32 m0, s22, 7168
    v_mad_u32_u16 v1, v11, s50, v3 op_sel:[1,0,0,0]
    buffer_load_dwordx4 v1, s[8:11], s25 offen lds
    s_add_u32 m0, s22, 8192
    v_mad_u32_u16 v0, v12, s50, v2 op_sel:[0,0,0,0]
    buffer_load_dwordx4 v0, s[8:11], s25 offen lds
    s_add_u32 m0, s22, 9216
    v_mad_u32_u16 v1, v12, s50, v3 op_sel:[1,0,0,0]
    buffer_load_dwordx4 v1, s[8:11], s25 offen lds
    s_add_u32 m0, s22, 10240
    v_mad_u32_u16 v0, v13, s50, v2 op_sel:[0,0,0,0]
    buffer_load_dwordx4 v0, s[8:11], s25 offen lds
    s_add_u32 m0, s22, 11264
    v_mad_u32_u16 v1, v13, s50, v3 op_sel:[1,0,0,0]
    buffer_load_dwordx4 v1, s[8:11], s25 offen lds
    s_cmp_lg_u32 s28, 2
    s_cbranch_scc1 K2_pfw_13
    s_cmp_lg_u32 s20, 9
    s_cbranch_scc1 K2_pfw_13
    v_mbcnt_lo_u32_b32 v77, -1, 0
    v_mbcnt_hi_u32_b32 v77, -1, v77
    v_mov_b32 v78, s51
    v_mad_u32_u24 v78, v78, 21, v77
    v_cmp_gt_u32 vcc, 21, v77
    v_mov_b32 v79, 640
    s_nop 0
    v_cndmask_b32 v78, v79, v78, vcc
    v_cmp_gt_u32 vcc, 640, v78
    v_lshlrev_b32 v78, 7, v78
    v_add_u32 v78, 327680, v78
    v_mov_b32 v77, 1073741824
    v_cndmask_b32 v78, v77, v78, vcc
    buffer_load_dword v76, v78, s[12:15], 0 offen sc1
K2_pfw_13:
K2_gn_3:
    s_mov_b32 s24, s25
    s_add_u32 s28, s28, 1
    s_branch K2_slice
K2_gap_F:
    s_nop 7
    v_cvt_pk_bf16_f32 v20, v36, v37
    v_cvt_pk_bf16_f32 v21, v38, v39
    v_cvt_pk_bf16_f32 v22, v40, v41
    v_cvt_pk_bf16_f32 v23, v42, v43
    v_cvt_pk_bf16_f32 v24, v44, v45
    v_cvt_pk_bf16_f32 v25, v46, v47
    v_cvt_pk_bf16_f32 v26, v48, v49
    v_cvt_pk_bf16_f32 v27, v50, v51
    ds_write_b128 v164, v[20:23]
    ds_write_b128 v164, v[24:27] offset:2560
    s_waitcnt vmcnt(0) lgkmcnt(0)
    s_barrier
    s_cmp_ge_u32 s20, 8
    s_cbranch_scc1 K2_gw_F
    ds_read_b128 v[20:23], v165 offset:0
    ds_read_b128 v[24:27], v165 offset:1024
    ds_read_b128 v[28:31], v165 offset:2048
    ds_read_b128 v[32:35], v165 offset:2560
    ds_read_b128 v[36:39], v165 offset:3584
    ds_read_b128 v[40:43], v165 offset:4608
    ds_read_b128 v[44:47], v165 offset:5136
    s_waitcnt lgkmcnt(6)
    v_mfma_f32_16x16x32_bf16 v[116:119], v[76:79], v[20:23], v[116:119]
    ds_read_b128 v[48:51], v165 offset:6160
    s_waitcnt lgkmcnt(6)
    v_mfma_f32_16x16x32_bf16 v[120:123], v[76:79], v[24:27], v[120:123]
    ds_read_b128 v[20:23], v165 offset:7184
    s_waitcnt lgkmcnt(6)
    v_mfma_f32_16x16x32_bf16 v[124:127], v[76:79], v[28:31], v[124:127]
    ds_read_b128 v[24:27], v165 offset:7696
    s_waitcnt lgkmcnt(6)
    v_mfma_f32_16x16x32_bf16 v[116:119], v[80:83], v[32:35], v[116:119]
    ds_read_b128 v[28:31], v165 offset:8720
    s_waitcnt lgkmcnt(6)
    v_mfma_f32_16x16x32_bf16 v[120:123], v[80:83], v[36:39], v[120:123]
    ds_read_b128 v[32:35], v165 offset:9744
    s_waitcnt lgkmcnt(6)
    v_mfma_f32_16x16x32_bf16 v[124:127], v[80:83], v[40:43], v[124:127]
    ds_read_b128 v[36:39], v165 offset:10272
    s_waitcnt lgkmcnt(6)
    v_mfma_f32_16x16x32_bf16 v[128:131], v[92:95], v[44:47], v[128:131]
    ds_read_b128 v[40:43], v165 offset:11296
    s_waitcnt lgkmcnt(6)
    v_mfma_f32_16x16x32_bf16 v[132:135], v[92:95], v[48:51], v[132:135]
    ds_read_b128 v[44:47], v165 offset:12320
    s_waitcnt lgkmcnt(6)
    v_mfma_f32_16x16x32_bf16 v[136:139], v[92:95], v[20:23], v[136:139]
    ds_read_b128 v[48:51], v165 offset:12832
    s_waitcnt lgkmcnt(6)
    v_mfma_f32_16x16x32_bf16 v[128:131], v[96:99], v[24:27], v[128:131]
    ds_read_b128 v[20:23], v165 offset:13856
    s_waitcnt lgkmcnt(6)
    v_mfma_f32_16x16x32_bf16 v[132:135], v[96:99], v[28:31], v[132:135]
    ds_read_b128 v[24:27], v165 offset:14880
    s_waitcnt lgkmcnt(6)
    v_mfma_f32_16x16x32_bf16 v[136:139], v[96:99], v[32:35], v[136:139]
    ds_read_b128 v[28:31], v165 offset:15408
    s_waitcnt lgkmcnt(6)
    v_mfma_f32_16x16x32_bf16 v[140:143], v[92:95], v[36:39], v[140:143]
    ds_read_b128 v[32:35], v165 offset:16432
    s_waitcnt lgkmcnt(6)
    v_mfma_f32_16x16x32_bf16 v[144:147], v[92:95], v[40:43], v[144:147]
    ds_read_b128 v[36:39], v165 offset:17456
    s_waitcnt lgkmcnt(6)
    v_mfma_f32_16x16x32_bf16 v[148:151], v[92:95], v[44:47], v[148:151]
    ds_read_b128 v[40:43], v165 offset:17968
    s_waitcnt lgkmcnt(6)
    v_mfma_f32_16x16x32_bf16 v[140:143], v[96:99], v[48:51], v[140:143]
    ds_read_b128 v[44:47], v165 offset:18992
    s_waitcnt lgkmcnt(6)
    v_mfma_f32_16x16x32_bf16 v[144:147], v[96:99], v[20:23], v[144:147]
    ds_read_b128 v[48:51], v165 offset:20016
    s_waitcnt lgkmcnt(6)
    v_mfma_f32_16x16x32_bf16 v[148:151], v[96:99], v[24:27], v[148:151]
    s_waitcnt lgkmcnt(5)
    v_mfma_f32_16x16x32_bf16 v[152:155], v[92:95], v[28:31], v[152:155]
    s_waitcnt lgkmcnt(4)
    v_mfma_f32_16x16x32_bf16 v[156:159], v[92:95], v[32:35], v[156:159]
    s_waitcnt lgkmcnt(3)
    v_mfma_f32_16x16x32_bf16 v[160:163], v[92:95], v[36:39], v[160:163]
    s_waitcnt lgkmcnt(2)
    v_mfma_f32_16x16x32_bf16 v[152:155], v[96:99], v[40:43], v[152:155]
    s_waitcnt lgkmcnt(1)
    v_mfma_f32_16x16x32_bf16 v[156:159], v[96:99], v[44:47], v[156:159]
    s_waitcnt lgkmcnt(0)
    v_mfma_f32_16x16x32_bf16 v[160:163], v[96:99], v[48:51], v[160:163]
    s_branch K2_gn_F
K2_gw_F:
K2_gn_F:
    s_cmp_eq_u32 s35, 0
    s_cbranch_scc1 K2_epi
    s_add_u32 s34, s34, 192
    s_cmp_ge_u32 s34, s36
    s_cbranch_scc1 K2_epi
    s_waitcnt vmcnt(0)
    s_branch K2_round
K2_epi:
    s_cmp_ge_u32 s20, 8
    s_cbranch_scc1 K2_epw
    v_mbcnt_lo_u32_b32 v2, -1, 0
    v_mbcnt_hi_u32_b32 v2, -1, v2
    v_and_b32 v3, 15, v2
    v_lshrrev_b32 v1, 4, v2
    v_lshlrev_b32 v1, 3, v1
    v_mul_u32_u24 v3, 1040, v3
    v_add_u32 v1, v1, v3
    s_lshl_b32 s38, s20, 5
    v_add_u32 v1, s38, v1
    s_mov_b32 s44, 0xbfb8aa3b
    s_mov_b32 s45, 0xbfb8aa3b
    s_mov_b32 s46, 1.0
    s_mov_b32 s47, 1.0
    v_pk_mul_f32 v[20:21], v[116:117], s[44:45]
    v_pk_mul_f32 v[22:23], v[118:119], s[44:45]
    v_exp_f32 v20, v20
    v_exp_f32 v21, v21
    v_exp_f32 v22, v22
    v_exp_f32 v23, v23
    v_cvt_pk_bf16_f32 v36, v116, v117
    v_cvt_pk_bf16_f32 v37, v118, v119
    v_pk_add_f32 v[20:21], v[20:21], s[46:47]
    v_pk_add_f32 v[22:23], v[22:23], s[46:47]
    v_rcp_f32 v20, v20
    v_rcp_f32 v21, v21
    v_rcp_f32 v22, v22
    v_rcp_f32 v23, v23
    s_nop 0
    v_pk_mul_f32 v[128:129], v[128:129], v[20:21]
    v_pk_mul_f32 v[130:131], v[130:131], v[22:23]
    v_cvt_pk_bf16_f32 v38, v128, v129
    v_cvt_pk_bf16_f32 v39, v130, v131
    v_pk_mul_f32 v[140:141], v[140:141], v[20:21]
    v_pk_mul_f32 v[142:143], v[142:143], v[22:23]
    v_cvt_pk_bf16_f32 v40, v140, v141
    v_cvt_pk_bf16_f32 v41, v142, v143
    v_pk_mul_f32 v[152:153], v[152:153], v[20:21]
    v_pk_mul_f32 v[154:155], v[154:155], v[22:23]
    v_cvt_pk_bf16_f32 v42, v152, v153
    v_cvt_pk_bf16_f32 v43, v154, v155
    ds_write_b64 v1, v[36:37] offset:0
    ds_write_b64 v1, v[38:39] offset:256
    ds_write_b64 v1, v[40:41] offset:512
    ds_write_b64 v1, v[42:43] offset:768
    v_pk_mul_f32 v[20:21], v[120:121], s[44:45]
    v_pk_mul_f32 v[22:23], v[122:123], s[44:45]
    v_exp_f32 v20, v20
    v_exp_f32 v21, v21
    v_exp_f32 v22, v22
    v_exp_f32 v23, v23
    v_cvt_pk_bf16_f32 v44, v120, v121
    v_cvt_pk_bf16_f32 v45, v122, v123
    v_pk_add_f32 v[20:21], v[20:21], s[46:47]
    v_pk_add_f32 v[22:23], v[22:23], s[46:47]
    v_rcp_f32 v20, v20
    v_rcp_f32 v21, v21
    v_rcp_f32 v22, v22
    v_rcp_f32 v23, v23
    s_waitcnt lgkmcnt(0)
    s_barrier
    v_pk_mul_f32 v[132:133], v[132:133], v[20:21]
    v_pk_mul_f32 v[134:135], v[134:135], v[22:23]
    v_cvt_pk_bf16_f32 v46, v132, v133
    v_cvt_pk_bf16_f32 v47, v134, v135
    v_pk_mul_f32 v[144:145], v[144:145], v[20:21]
    v_pk_mul_f32 v[146:147], v[146:147], v[22:23]
    v_cvt_pk_bf16_f32 v48, v144, v145
    v_cvt_pk_bf16_f32 v49, v146, v147
    v_pk_mul_f32 v[156:157], v[156:157], v[20:21]
    v_pk_mul_f32 v[158:159], v[158:159], v[22:23]
    v_cvt_pk_bf16_f32 v50, v156, v157
    v_cvt_pk_bf16_f32 v51, v158, v159
    ds_write_b64 v1, v[44:45] offset:16640
    ds_write_b64 v1, v[46:47] offset:16896
    ds_write_b64 v1, v[48:49] offset:17152
    ds_write_b64 v1, v[50:51] offset:17408
    v_pk_mul_f32 v[20:21], v[124:125], s[44:45]
    v_pk_mul_f32 v[22:23], v[126:127], s[44:45]
    v_exp_f32 v20, v20
    v_exp_f32 v21, v21
    v_exp_f32 v22, v22
    v_exp_f32 v23, v23
    v_cvt_pk_bf16_f32 v52, v124, v125
    v_cvt_pk_bf16_f32 v53, v126, v127
    v_pk_add_f32 v[20:21], v[20:21], s[46:47]
    v_pk_add_f32 v[22:23], v[22:23], s[46:47]
    v_rcp_f32 v20, v20
    v_rcp_f32 v21, v21
    v_rcp_f32 v22, v22
    v_rcp_f32 v23, v23
    s_waitcnt lgkmcnt(0)
    s_barrier
    v_pk_mul_f32 v[136:137], v[136:137], v[20:21]
    v_pk_mul_f32 v[138:139], v[138:139], v[22:23]
    v_cvt_pk_bf16_f32 v54, v136, v137
    v_cvt_pk_bf16_f32 v55, v138, v139
    v_pk_mul_f32 v[148:149], v[148:149], v[20:21]
    v_pk_mul_f32 v[150:151], v[150:151], v[22:23]
    v_cvt_pk_bf16_f32 v56, v148, v149
    v_cvt_pk_bf16_f32 v57, v150, v151
    v_pk_mul_f32 v[160:161], v[160:161], v[20:21]
    v_pk_mul_f32 v[162:163], v[162:163], v[22:23]
    v_cvt_pk_bf16_f32 v58, v160, v161
    v_cvt_pk_bf16_f32 v59, v162, v163
    ds_write_b64 v1, v[52:53] offset:33280
    ds_write_b64 v1, v[54:55] offset:33536
    ds_write_b64 v1, v[56:57] offset:33792
    ds_write_b64 v1, v[58:59] offset:34048
    v_mbcnt_lo_u32_b32 v2, -1, 0
    v_mbcnt_hi_u32_b32 v2, -1, v2
    v_lshlrev_b32 v2, 4, v2
    s_add_u32 s38, s20, 32
    s_mul_i32 s37, s38, 1040
    v_add_u32 v3, s37, v2
    s_mul_i32 s40, s52, 40960
    s_lshl_b32 s38, s38, 10
    s_add_u32 s40, s40, s38
    s_waitcnt lgkmcnt(0)
    s_barrier
    ds_read_b128 v[20:23], v3
    s_waitcnt lgkmcnt(0)
    buffer_store_dwordx4 v[20:23], v2, s[16:19], s40 offen sc1
    s_branch K2_fin
K2_epw:
    v_mbcnt_lo_u32_b32 v2, -1, 0
    v_mbcnt_hi_u32_b32 v2, -1, v2
    v_lshlrev_b32 v2, 4, v2
    s_sub_u32 s38, s20, 8
    s_lshl_b32 s38, s38, 3
    s_mul_i32 s37, s38, 1040
    v_add_u32 v3, s37, v2
    s_mul_i32 s40, s52, 40960
    s_lshl_b32 s38, s38, 10
    s_add_u32 s40, s40, s38
    s_add_u32 s41, s40, 4096
    s_add_u32 s42, s40, 16384
    s_add_u32 s43, s42, 4096
    s_barrier
    ds_read_b128 v[20:23], v3 offset:0
    ds_read_b128 v[24:27], v3 offset:1040
    ds_read_b128 v[28:31], v3 offset:2080
    ds_read_b128 v[32:35], v3 offset:3120
    ds_read_b128 v[36:39], v3 offset:4160
    ds_read_b128 v[40:43], v3 offset:5200
    ds_read_b128 v[44:47], v3 offset:6240
    ds_read_b128 v[48:51], v3 offset:7280
    s_waitcnt lgkmcnt(7)
    buffer_store_dwordx4 v[20:23], v2, s[16:19], s40 offen offset:0 sc1
    s_waitcnt lgkmcnt(6)
    buffer_store_dwordx4 v[24:27], v2, s[16:19], s40 offen offset:1024 sc1
    s_waitcnt lgkmcnt(5)
    buffer_store_dwordx4 v[28:31], v2, s[16:19], s40 offen offset:2048 sc1
    s_waitcnt lgkmcnt(4)
    buffer_store_dwordx4 v[32:35], v2, s[16:19], s40 offen offset:3072 sc1
    s_waitcnt lgkmcnt(3)
    buffer_store_dwordx4 v[36:39], v2, s[16:19], s41 offen offset:0 sc1
    s_waitcnt lgkmcnt(2)
    buffer_store_dwordx4 v[40:43], v2, s[16:19], s41 offen offset:1024 sc1
    s_waitcnt lgkmcnt(1)
    buffer_store_dwordx4 v[44:47], v2, s[16:19], s41 offen offset:2048 sc1
    s_waitcnt lgkmcnt(0)
    buffer_store_dwordx4 v[48:51], v2, s[16:19], s41 offen offset:3072 sc1
    s_barrier
    ds_read_b128 v[52:55], v3 offset:16640
    ds_read_b128 v[56:59], v3 offset:17680
    ds_read_b128 v[60:63], v3 offset:18720
    ds_read_b128 v[64:67], v3 offset:19760
    ds_read_b128 v[68:71], v3 offset:20800
    ds_read_b128 v[72:75], v3 offset:21840
    ds_read_b128 v[76:79], v3 offset:22880
    ds_read_b128 v[80:83], v3 offset:23920
    s_waitcnt lgkmcnt(7)
    buffer_store_dwordx4 v[52:55], v2, s[16:19], s42 offen offset:0 sc1
    s_waitcnt lgkmcnt(6)
    buffer_store_dwordx4 v[56:59], v2, s[16:19], s42 offen offset:1024 sc1
    s_waitcnt lgkmcnt(5)
    buffer_store_dwordx4 v[60:63], v2, s[16:19], s42 offen offset:2048 sc1
    s_waitcnt lgkmcnt(4)
    buffer_store_dwordx4 v[64:67], v2, s[16:19], s42 offen offset:3072 sc1
    s_waitcnt lgkmcnt(3)
    buffer_store_dwordx4 v[68:71], v2, s[16:19], s43 offen offset:0 sc1
    s_waitcnt lgkmcnt(2)
    buffer_store_dwordx4 v[72:75], v2, s[16:19], s43 offen offset:1024 sc1
    s_waitcnt lgkmcnt(1)
    buffer_store_dwordx4 v[76:79], v2, s[16:19], s43 offen offset:2048 sc1
    s_waitcnt lgkmcnt(0)
    buffer_store_dwordx4 v[80:83], v2, s[16:19], s43 offen offset:3072 sc1
    s_barrier
K2_fin:
    s_or_b32 s37, s2, s20
    s_cmp_lg_u32 s37, 0
    s_cbranch_scc1 K2_noep
    v_mov_b32 v2, 491520
    v_mov_b32 v3, s63
    s_mov_b64 exec, 1
    buffer_store_dword v3, v2, s[12:15], 0 offen sc1
    s_mov_b64 exec, -1
K2_noep:
    s_waitcnt vmcnt(0) lgkmcnt(0)
    s_endpgm
K2_overflow:
    s_cmp_lg_u32 s35, 0
    s_cbranch_scc1 K2_nover
    s_mov_b32 s35, 1
    s_mov_b32 s34, 0
    v_lshlrev_b32 v65, 2, v58
    v_add_u32 v65, 151168, v65
    ds_write_b32 v65, v64
    s_waitcnt lgkmcnt(0)
    s_barrier
    v_mov_b32 v61, 0
    v_mov_b32 v63, 0
    s_mov_b32 s37, 0
K2_pl:
    s_lshl_b32 s38, s37, 2
    s_add_u32 s38, s38, 151168
    v_mov_b32 v66, s38
    ds_read_b32 v66, v66
    v_cmp_lt_u32 vcc, s37, v58
    s_waitcnt lgkmcnt(0)
    v_add_u32 v63, v63, v66
    v_cndmask_b32 v66, 0, v66, vcc
    v_add_u32 v61, v61, v66
    s_add_u32 s37, s37, 1
    s_cmp_lt_u32 s37, 160
    s_cbranch_scc1 K2_pl
    s_barrier
    ds_write_b32 v65, v61
    v_readfirstlane_b32 s36, v63
    s_waitcnt vmcnt(0) lgkmcnt(0)
    s_barrier
    s_branch K2_round
K2_done:
    s_endpgm
.section .rodata,"a"
.p2align 7
.p2align 6
.amdhsa_kernel standalone__tensor_product_equiv_equiformer__graph_kernel
  .amdhsa_next_free_vgpr 166
  .amdhsa_next_free_sgpr 72
  .amdhsa_accum_offset 168
  .amdhsa_group_segment_fixed_size 0
  .amdhsa_kernarg_size 96
  .amdhsa_user_sgpr_count 2
  .amdhsa_user_sgpr_kernarg_segment_ptr 1
  .amdhsa_system_sgpr_workgroup_id_x 1
.end_amdhsa_kernel
```
